```python
import torch

def _softmax(x, axis=-1):
    return torch.softmax(x, dim=axis)
def _gelu(x):
    return torch.nn.functional.gelu(x, approximate="tanh")
def _silu(x):
    return torch.nn.functional.silu(x)
def _sigmoid(x):
    return torch.sigmoid(x)
def _layernorm(x, axis=-1, eps=1e-5):
    m = x.mean(dim=axis, keepdim=True)
    v = x.var(dim=axis, keepdim=True, unbiased=False)
    return (x - m) / torch.sqrt(v + eps)
def _scatter_add(tgt, idx, src, axis=0):
    return tgt.clone().index_add_(axis, idx, src)
def _segment_sum(src, seg, n):
    out = torch.zeros((n,) + src.shape[1:], dtype=src.dtype)
    return out.index_add_(0, seg, src)
def _pad(x, pw):
    flat = tuple(v for pair in reversed(pw) for v in pair)
    return torch.nn.functional.pad(x, flat)

kernel_name = 'gated_mix__mha_block__glu_gated_geglu__prompt'

def setup_inputs():

    _w = (lambda a: (lambda t: t.to(torch.bfloat16) if t.is_floating_point() else t)(torch.as_tensor(a)))
    def _A_setup():
        B, S, D, H = 1, 2048, 640, 32
        return {
            "x": _w((lambda *s: torch.randn(*s, dtype=torch.bfloat16) * 0.05)(B, S, D)),
            "wqkv": _w((lambda *s: torch.randn(*s, dtype=torch.bfloat16) * 0.8)(D, 3 * D)),
            "wo": _w((lambda *s: torch.randn(*s, dtype=torch.bfloat16) * 0.05)(D, D)),
        }
    _A_in = _A_setup()

    def _B_setup():
        B, S, Dm, Df = 1, 2048, 640, 1536
        return {
            "x": _w((lambda *s: torch.randn(*s, dtype=torch.bfloat16) * 0.05)(B, S, Dm)),
            "w_gate": _w((lambda *s: torch.randn(*s, dtype=torch.bfloat16) * 3.2)(Dm, Df) * (Dm ** -0.5)),
            "w_up": _w((lambda *s: torch.randn(*s, dtype=torch.bfloat16) * 3.2)(Dm, Df) * (Dm ** -0.5)),
            "w_down": _w((lambda *s: torch.randn(*s, dtype=torch.bfloat16) * 3.2)(Df, Dm) * (Df ** -0.5)),
        }
    _B_in = _B_setup()

    return {
        "A_x": _A_in["x"],
        "A_wqkv": _A_in["wqkv"],
        "A_wo": _A_in["wo"],
        "B_x": _B_in["x"],
        "B_w_gate": _B_in["w_gate"],
        "B_w_up": _B_in["w_up"],
        "B_w_down": _B_in["w_down"],
        "gate_w": _w((lambda *s: torch.randn(*s, dtype=torch.bfloat16) * 0.05)(640) * 16.0),
    }

def reference(A_x, A_wqkv, A_wo, B_x, B_w_gate, B_w_up, B_w_down, gate_w):
    def _A_ref(x, wqkv, wo):
        B, S, D = x.shape
        H = 32
        Dh = D // H
        qkv = (lambda x, *d: x.permute(*d))((x @ wqkv).reshape(B, S, 3, H, Dh), 2, 0, 3, 1, 4)
        q, k, v = qkv[0], qkv[1], qkv[2]
        scores = torch.einsum("bhqd,bhkd->bhqk", q, k) * (Dh ** -0.5)
        p = _softmax(scores, axis=-1)
        o = torch.einsum("bhqk,bhkd->bhqd", p, v)
        return (lambda x, *d: x.permute(*d))(o, 0, 2, 1, 3).reshape(B, S, D) @ wo

    def _B_ref(x, w_gate, w_up, w_down):
        g = torch.einsum("bsd,df->bsf", x, w_gate)
        u = torch.einsum("bsd,df->bsf", x, w_up)
        h = _gelu(g) * u
        return torch.einsum("bsf,fd->bsd", h, w_down)

    x = A_x
    g = _sigmoid((x * gate_w).sum(-1, keepdims=True))
    a = _A_ref(x, A_wqkv, A_wo)
    b = _B_ref(x, B_w_gate, B_w_up, B_w_down)
    return g * a + (1 - g) * b
```

```asm
; @launch grid=(256,1,1) block=(512,1,1) lds=162192
.amdgcn_target "amdgcn-amd-amdhsa--gfx950"
.text
.globl gated_mix__mha_block__glu_gated_geglu__prompt_kernel
.p2align 8
.type gated_mix__mha_block__glu_gated_geglu__prompt_kernel,@function
gated_mix__mha_block__glu_gated_geglu__prompt_kernel:
    s_cmp_ge_u32 s2, 256
    s_cbranch_scc1 gated_mix__mha_block__glu_gated_geglu__prompt_kernel_end
    s_load_dwordx8 s[4:11], s[0:1], 0
    s_load_dwordx8 s[12:19], s[0:1], 32
    s_load_dwordx2 s[48:49], s[0:1], 80
    s_and_b32 s23, s2, 1
    s_lshl_b32 s23, s23, 2
    s_lshr_b32 s24, s2, 3
    s_and_b32 s25, s24, 3
    s_add_u32 s20, s23, s25
    s_bfe_u32 s23, s2, 0x20001
    s_lshr_b32 s24, s24, 2
    s_lshl_b32 s25, s24, 2
    s_add_u32 s21, s25, s23
    s_mov_b32 s29, s24
    s_cmp_ge_u32 s24, 3
    s_cbranch_scc0 gated_mix__mha_block__glu_gated_geglu__prompt_kernel_dec_done
    s_lshl_b32 s25, s23, 2
    s_add_u32 s21, s25, s24
    s_sub_u32 s21, s21, 3
    s_cmp_eq_u32 s24, 7
    s_cselect_b32 s29, 4, 3
gated_mix__mha_block__glu_gated_geglu__prompt_kernel_dec_done:
    v_lshrrev_b32 v1, 6, v0
    v_and_b32 v2, 63, v0
    v_readfirstlane_b32 s22, v1
    s_movk_i32 s26, 3840
    s_mul_i32 s27, s21, 160
    s_add_u32 s28, s27, 80
    s_cmp_ge_u32 s22, 4
    s_cbranch_scc1 gated_mix__mha_block__glu_gated_geglu__prompt_kernel_loader
    s_cmp_eq_u32 s29, 4
    s_cbranch_scc1 gated_mix__mha_block__glu_gated_geglu__prompt_kernel_idlec
    s_cmp_eq_u32 s29, 3
    s_cbranch_scc1 gated_mix__mha_block__glu_gated_geglu__prompt_kernel_f6c
    v_lshrrev_b32 v3, 3, v2
    v_lshrrev_b32 v4, 4, v2
    v_and_b32 v5, 7, v2
    v_xor_b32 v5, v5, v4
    v_xor_b32 v6, 4, v5
    s_lshl_b32 s23, s22, 6
    v_add_u32 v3, s23, v3
    v_mul_u32_u24 v3, 1280, v3
    v_lshl_add_u32 v5, v5, 4, v3
    v_lshl_add_u32 v6, v6, 4, v3
    v_add_u32 v70, 0, v5
    v_add_u32 v71, 10240, v6
    v_add_u32 v72, 20480, v5
    v_add_u32 v73, 30720, v6
    v_add_u32 v74, 40960, v5
    v_add_u32 v75, 51200, v6
    v_add_u32 v76, 61440, v5
    v_add_u32 v77, 71680, v6
    s_mul_i32 s45, s20, 327680
    s_lshl_b32 s24, s22, 13
    s_waitcnt lgkmcnt(0)
    s_mov_b32 s32, s4
    s_and_b32 s33, s5, 0xffff
    s_mov_b32 s34, 2621440
    s_mov_b32 s35, 0x20000
    s_mov_b32 s40, s48
    s_and_b32 s41, s49, 0xffff
    s_mov_b32 s42, 26214400
    s_mov_b32 s43, 0x20000
    s_add_u32 m0, s24, 0
    s_nop 0
    buffer_load_dwordx4 v70, s[32:35], s45 offen lds
    s_add_u32 m0, s24, 1024
    s_nop 0
    buffer_load_dwordx4 v71, s[32:35], s45 offen lds
    s_add_u32 m0, s24, 2048
    s_nop 0
    buffer_load_dwordx4 v72, s[32:35], s45 offen lds
    s_add_u32 m0, s24, 3072
    s_nop 0
    buffer_load_dwordx4 v73, s[32:35], s45 offen lds
    s_add_u32 m0, s24, 4096
    s_nop 0
    buffer_load_dwordx4 v74, s[32:35], s45 offen lds
    s_add_u32 m0, s24, 5120
    s_nop 0
    buffer_load_dwordx4 v75, s[32:35], s45 offen lds
    s_add_u32 m0, s24, 6144
    s_nop 0
    buffer_load_dwordx4 v76, s[32:35], s45 offen lds
    s_add_u32 m0, s24, 7168
    s_nop 0
    buffer_load_dwordx4 v77, s[32:35], s45 offen lds
    s_add_u32 s45, s45, 128
    s_add_u32 m0, s24, 53376
    s_nop 0
    buffer_load_dwordx4 v70, s[32:35], s45 offen lds
    s_add_u32 m0, s24, 54400
    s_nop 0
    buffer_load_dwordx4 v71, s[32:35], s45 offen lds
    s_add_u32 m0, s24, 55424
    s_nop 0
    buffer_load_dwordx4 v72, s[32:35], s45 offen lds
    s_add_u32 m0, s24, 56448
    s_nop 0
    buffer_load_dwordx4 v73, s[32:35], s45 offen lds
    s_add_u32 m0, s24, 57472
    s_nop 0
    buffer_load_dwordx4 v74, s[32:35], s45 offen lds
    s_add_u32 m0, s24, 58496
    s_nop 0
    buffer_load_dwordx4 v75, s[32:35], s45 offen lds
    s_add_u32 m0, s24, 59520
    s_nop 0
    buffer_load_dwordx4 v76, s[32:35], s45 offen lds
    s_add_u32 m0, s24, 60544
    s_nop 0
    buffer_load_dwordx4 v77, s[32:35], s45 offen lds
    s_add_u32 s45, s45, 128
    v_and_b32 v3, 31, v2
    v_lshrrev_b32 v4, 5, v2
    s_lshl_b32 s23, s22, 6
    v_add_u32 v5, s23, v3
    v_lshlrev_b32 v5, 7, v5
    v_bfe_u32 v6, v3, 1, 3
    v_or_b32 v7, 0, v4
    v_xor_b32 v7, v7, v6
    v_lshl_add_u32 v64, v7, 4, v5
    v_or_b32 v7, 2, v4
    v_xor_b32 v7, v7, v6
    v_lshl_add_u32 v65, v7, 4, v5
    v_or_b32 v7, 4, v4
    v_xor_b32 v7, v7, v6
    v_lshl_add_u32 v66, v7, 4, v5
    v_or_b32 v7, 6, v4
    v_xor_b32 v7, v7, v6
    v_lshl_add_u32 v67, v7, 4, v5
    v_bfe_u32 v5, v2, 4, 1
    v_mul_u32_u24 v5, 160, v5
    v_bfe_u32 v6, v2, 2, 2
    v_lshl_add_u32 v6, v4, 3, v6
    v_mul_u32_u24 v6, 320, v6
    v_and_b32 v7, 3, v2
    v_lshlrev_b32 v7, 3, v7
    v_add3_u32 v5, v5, v6, v7
    v_add_u32 v68, 32768, v5
    v_lshlrev_b32 v7, 2, v7
    v_add3_u32 v69, v68, v7, 32
    v_mov_b32 v96, 0
    v_mov_b32 v97, 0
    v_mov_b32 v98, 0
    v_mov_b32 v99, 0
    v_mov_b32 v100, 0
    v_mov_b32 v101, 0
    v_mov_b32 v102, 0
    v_mov_b32 v103, 0
    v_mov_b32 v104, 0
    v_mov_b32 v105, 0
    v_mov_b32 v106, 0
    v_mov_b32 v107, 0
    v_mov_b32 v108, 0
    v_mov_b32 v109, 0
    v_mov_b32 v110, 0
    v_mov_b32 v111, 0
    v_mov_b32 v112, 0
    v_mov_b32 v113, 0
    v_mov_b32 v114, 0
    v_mov_b32 v115, 0
    v_mov_b32 v116, 0
    v_mov_b32 v117, 0
    v_mov_b32 v118, 0
    v_mov_b32 v119, 0
    v_mov_b32 v120, 0
    v_mov_b32 v121, 0
    v_mov_b32 v122, 0
    v_mov_b32 v123, 0
    v_mov_b32 v124, 0
    v_mov_b32 v125, 0
    v_mov_b32 v126, 0
    v_mov_b32 v127, 0
    v_mov_b32 v128, 0
    v_mov_b32 v129, 0
    v_mov_b32 v130, 0
    v_mov_b32 v131, 0
    v_mov_b32 v132, 0
    v_mov_b32 v133, 0
    v_mov_b32 v134, 0
    v_mov_b32 v135, 0
    v_mov_b32 v136, 0
    v_mov_b32 v137, 0
    v_mov_b32 v138, 0
    v_mov_b32 v139, 0
    v_mov_b32 v140, 0
    v_mov_b32 v141, 0
    v_mov_b32 v142, 0
    v_mov_b32 v143, 0
    v_mov_b32 v144, 0
    v_mov_b32 v145, 0
    v_mov_b32 v146, 0
    v_mov_b32 v147, 0
    v_mov_b32 v148, 0
    v_mov_b32 v149, 0
    v_mov_b32 v150, 0
    v_mov_b32 v151, 0
    v_mov_b32 v152, 0
    v_mov_b32 v153, 0
    v_mov_b32 v154, 0
    v_mov_b32 v155, 0
    v_mov_b32 v156, 0
    v_mov_b32 v157, 0
    v_mov_b32 v158, 0
    v_mov_b32 v159, 0
    v_mov_b32 v160, 0
    v_mov_b32 v161, 0
    v_mov_b32 v162, 0
    v_mov_b32 v163, 0
    v_mov_b32 v164, 0
    v_mov_b32 v165, 0
    v_mov_b32 v166, 0
    v_mov_b32 v167, 0
    v_mov_b32 v168, 0
    v_mov_b32 v169, 0
    v_mov_b32 v170, 0
    v_mov_b32 v171, 0
    v_mov_b32 v172, 0
    v_mov_b32 v173, 0
    v_mov_b32 v174, 0
    v_mov_b32 v175, 0
    v_mov_b32 v176, 0
    v_mov_b32 v177, 0
    v_mov_b32 v178, 0
    v_mov_b32 v179, 0
    v_mov_b32 v180, 0
    v_mov_b32 v181, 0
    v_mov_b32 v182, 0
    v_mov_b32 v183, 0
    v_mov_b32 v184, 0
    v_mov_b32 v185, 0
    v_mov_b32 v186, 0
    v_mov_b32 v187, 0
    v_mov_b32 v188, 0
    v_mov_b32 v189, 0
    v_mov_b32 v190, 0
    v_mov_b32 v191, 0
    v_mov_b32 v192, 0
    v_mov_b32 v193, 0
    v_mov_b32 v194, 0
    v_mov_b32 v195, 0
    v_mov_b32 v196, 0
    v_mov_b32 v197, 0
    v_mov_b32 v198, 0
    v_mov_b32 v199, 0
    v_mov_b32 v200, 0
    v_mov_b32 v201, 0
    v_mov_b32 v202, 0
    v_mov_b32 v203, 0
    v_mov_b32 v204, 0
    v_mov_b32 v205, 0
    v_mov_b32 v206, 0
    v_mov_b32 v207, 0
    v_mov_b32 v208, 0
    v_mov_b32 v209, 0
    v_mov_b32 v210, 0
    v_mov_b32 v211, 0
    v_mov_b32 v212, 0
    v_mov_b32 v213, 0
    v_mov_b32 v214, 0
    v_mov_b32 v215, 0
    v_mov_b32 v216, 0
    v_mov_b32 v217, 0
    v_mov_b32 v218, 0
    v_mov_b32 v219, 0
    v_mov_b32 v220, 0
    v_mov_b32 v221, 0
    v_mov_b32 v222, 0
    v_mov_b32 v223, 0
    v_mov_b32 v224, 0
    v_mov_b32 v225, 0
    v_mov_b32 v226, 0
    v_mov_b32 v227, 0
    v_mov_b32 v228, 0
    v_mov_b32 v229, 0
    v_mov_b32 v230, 0
    v_mov_b32 v231, 0
    v_mov_b32 v232, 0
    v_mov_b32 v233, 0
    v_mov_b32 v234, 0
    v_mov_b32 v235, 0
    v_mov_b32 v236, 0
    v_mov_b32 v237, 0
    v_mov_b32 v238, 0
    v_mov_b32 v239, 0
    v_mov_b32 v240, 0
    v_mov_b32 v241, 0
    v_mov_b32 v242, 0
    v_mov_b32 v243, 0
    v_mov_b32 v244, 0
    v_mov_b32 v245, 0
    v_mov_b32 v246, 0
    v_mov_b32 v247, 0
    v_mov_b32 v248, 0
    v_mov_b32 v249, 0
    v_mov_b32 v250, 0
    v_mov_b32 v251, 0
    v_mov_b32 v252, 0
    v_mov_b32 v253, 0
    v_mov_b32 v254, 0
    v_mov_b32 v255, 0
    s_cmp_eq_u32 s29, 2
    s_cbranch_scc1 gated_mix__mha_block__glu_gated_geglu__prompt_kernel_vblock
    s_waitcnt vmcnt(8)
    s_barrier
    ds_read_b128 v[28:31], v64 offset:0
    ds_read_b64_tr_b16 v[8:9], v68 offset:0
    ds_read_b64_tr_b16 v[10:11], v68 offset:1280
    ds_read_b128 v[32:35], v64 offset:4096
    ds_read_b64_tr_b16 v[12:13], v68 offset:40
    ds_read_b64_tr_b16 v[14:15], v68 offset:1320
    ds_read_b64_tr_b16 v[16:17], v68 offset:80
    ds_read_b64_tr_b16 v[18:19], v68 offset:1360
    ds_read_b64_tr_b16 v[20:21], v68 offset:120
    ds_read_b64_tr_b16 v[22:23], v68 offset:1400
    ds_read_b64_tr_b16 v[24:25], v69 offset:0
    ds_read_b64_tr_b16 v[26:27], v69 offset:1280
    s_mov_b32 s47, 0
    s_mov_b32 s44, 0
    s_mov_b32 s84, 53376
    s_mov_b32 s85, 4294860544
.p2align 6
gated_mix__mha_block__glu_gated_geglu__prompt_kernel_loop_qk:
    s_waitcnt lgkmcnt(8)
    v_mfma_f32_32x32x16_bf16 v[96:111], v[8:11], v[28:31], v[96:111]
    ds_read_b128 v[56:59], v65 offset:0
    ds_read_b64_tr_b16 v[36:37], v68 offset:5120
    v_mfma_f32_32x32x16_bf16 v[176:191], v[8:11], v[32:35], v[176:191]
    ds_read_b64_tr_b16 v[38:39], v68 offset:6400
    ds_read_b128 v[60:63], v65 offset:4096
    s_waitcnt lgkmcnt(10)
    v_mfma_f32_32x32x16_bf16 v[112:127], v[12:15], v[28:31], v[112:127]
    ds_read_b64_tr_b16 v[40:41], v68 offset:5160
    ds_read_b64_tr_b16 v[42:43], v68 offset:6440
    v_mfma_f32_32x32x16_bf16 v[192:207], v[12:15], v[32:35], v[192:207]
    ds_read_b64_tr_b16 v[44:45], v68 offset:5200
    ds_read_b64_tr_b16 v[46:47], v68 offset:6480
    s_waitcnt lgkmcnt(12)
    v_mfma_f32_32x32x16_bf16 v[128:143], v[16:19], v[28:31], v[128:143]
    ds_read_b64_tr_b16 v[48:49], v68 offset:5240
    ds_read_b64_tr_b16 v[50:51], v68 offset:6520
    v_mfma_f32_32x32x16_bf16 v[208:223], v[16:19], v[32:35], v[208:223]
    ds_read_b64_tr_b16 v[52:53], v69 offset:5120
    ds_read_b64_tr_b16 v[54:55], v69 offset:6400
    s_waitcnt lgkmcnt(14)
    v_mfma_f32_32x32x16_bf16 v[144:159], v[20:23], v[28:31], v[144:159]
    v_mfma_f32_32x32x16_bf16 v[224:239], v[20:23], v[32:35], v[224:239]
    s_waitcnt lgkmcnt(12)
    v_mfma_f32_32x32x16_bf16 v[160:175], v[24:27], v[28:31], v[160:175]
    v_mfma_f32_32x32x16_bf16 v[240:255], v[24:27], v[32:35], v[240:255]
    s_waitcnt lgkmcnt(8)
    v_mfma_f32_32x32x16_bf16 v[96:111], v[36:39], v[56:59], v[96:111]
    ds_read_b128 v[28:31], v66 offset:0
    ds_read_b64_tr_b16 v[8:9], v68 offset:10240
    v_mfma_f32_32x32x16_bf16 v[176:191], v[36:39], v[60:63], v[176:191]
    ds_read_b64_tr_b16 v[10:11], v68 offset:11520
    ds_read_b128 v[32:35], v66 offset:4096
    s_waitcnt lgkmcnt(10)
    v_mfma_f32_32x32x16_bf16 v[112:127], v[40:43], v[56:59], v[112:127]
    ds_read_b64_tr_b16 v[12:13], v68 offset:10280
    ds_read_b64_tr_b16 v[14:15], v68 offset:11560
    v_mfma_f32_32x32x16_bf16 v[192:207], v[40:43], v[60:63], v[192:207]
    ds_read_b64_tr_b16 v[16:17], v68 offset:10320
    ds_read_b64_tr_b16 v[18:19], v68 offset:11600
    s_waitcnt lgkmcnt(12)
    v_mfma_f32_32x32x16_bf16 v[128:143], v[44:47], v[56:59], v[128:143]
    ds_read_b64_tr_b16 v[20:21], v68 offset:10360
    ds_read_b64_tr_b16 v[22:23], v68 offset:11640
    v_mfma_f32_32x32x16_bf16 v[208:223], v[44:47], v[60:63], v[208:223]
    ds_read_b64_tr_b16 v[24:25], v69 offset:10240
    ds_read_b64_tr_b16 v[26:27], v69 offset:11520
    s_waitcnt lgkmcnt(14)
    v_mfma_f32_32x32x16_bf16 v[144:159], v[48:51], v[56:59], v[144:159]
    v_mfma_f32_32x32x16_bf16 v[224:239], v[48:51], v[60:63], v[224:239]
    s_waitcnt lgkmcnt(12)
    v_mfma_f32_32x32x16_bf16 v[160:175], v[52:55], v[56:59], v[160:175]
    v_mfma_f32_32x32x16_bf16 v[240:255], v[52:55], v[60:63], v[240:255]
    s_waitcnt lgkmcnt(8)
    v_mfma_f32_32x32x16_bf16 v[96:111], v[8:11], v[28:31], v[96:111]
    ds_read_b128 v[56:59], v67 offset:0
    ds_read_b64_tr_b16 v[36:37], v68 offset:15360
    v_mfma_f32_32x32x16_bf16 v[176:191], v[8:11], v[32:35], v[176:191]
    ds_read_b64_tr_b16 v[38:39], v68 offset:16640
    ds_read_b128 v[60:63], v67 offset:4096
    s_waitcnt lgkmcnt(10)
    v_mfma_f32_32x32x16_bf16 v[112:127], v[12:15], v[28:31], v[112:127]
    ds_read_b64_tr_b16 v[40:41], v68 offset:15400
    ds_read_b64_tr_b16 v[42:43], v68 offset:16680
    v_mfma_f32_32x32x16_bf16 v[192:207], v[12:15], v[32:35], v[192:207]
    ds_read_b64_tr_b16 v[44:45], v68 offset:15440
    ds_read_b64_tr_b16 v[46:47], v68 offset:16720
    s_waitcnt lgkmcnt(12)
    v_mfma_f32_32x32x16_bf16 v[128:143], v[16:19], v[28:31], v[128:143]
    ds_read_b64_tr_b16 v[48:49], v68 offset:15480
    ds_read_b64_tr_b16 v[50:51], v68 offset:16760
    v_mfma_f32_32x32x16_bf16 v[208:223], v[16:19], v[32:35], v[208:223]
    ds_read_b64_tr_b16 v[52:53], v69 offset:15360
    ds_read_b64_tr_b16 v[54:55], v69 offset:16640
    s_waitcnt lgkmcnt(14)
    v_mfma_f32_32x32x16_bf16 v[144:159], v[20:23], v[28:31], v[144:159]
    v_mfma_f32_32x32x16_bf16 v[224:239], v[20:23], v[32:35], v[224:239]
    s_waitcnt lgkmcnt(12)
    v_mfma_f32_32x32x16_bf16 v[160:175], v[24:27], v[28:31], v[160:175]
    v_mfma_f32_32x32x16_bf16 v[240:255], v[24:27], v[32:35], v[240:255]
    s_waitcnt lgkmcnt(8)
    v_mfma_f32_32x32x16_bf16 v[96:111], v[36:39], v[56:59], v[96:111]
    v_mfma_f32_32x32x16_bf16 v[176:191], v[36:39], v[60:63], v[176:191]
    s_waitcnt lgkmcnt(0)
    s_add_u32 s44, s44, 1
    s_cmp_eq_u32 s44, 3
    s_cselect_b32 s23, s85, s84
    s_cselect_b32 s44, 0, s44
    s_cmp_eq_u32 s47, 0
    s_cbranch_scc0 gated_mix__mha_block__glu_gated_geglu__prompt_kernel_nw_qk
    s_waitcnt vmcnt(0)
gated_mix__mha_block__glu_gated_geglu__prompt_kernel_nw_qk:
    s_barrier
    v_add_u32 v64, s23, v64
    v_add_u32 v65, s23, v65
    v_add_u32 v66, s23, v66
    v_add_u32 v67, s23, v67
    v_add_u32 v68, s23, v68
    v_add_u32 v69, s23, v69
    v_mfma_f32_32x32x16_bf16 v[112:127], v[40:43], v[56:59], v[112:127]
    ds_read_b128 v[28:31], v64 offset:0
    ds_read_b64_tr_b16 v[8:9], v68 offset:0
    v_mfma_f32_32x32x16_bf16 v[192:207], v[40:43], v[60:63], v[192:207]
    ds_read_b64_tr_b16 v[10:11], v68 offset:1280
    ds_read_b128 v[32:35], v64 offset:4096
    v_mfma_f32_32x32x16_bf16 v[128:143], v[44:47], v[56:59], v[128:143]
    ds_read_b64_tr_b16 v[12:13], v68 offset:40
    ds_read_b64_tr_b16 v[14:15], v68 offset:1320
    v_mfma_f32_32x32x16_bf16 v[208:223], v[44:47], v[60:63], v[208:223]
    ds_read_b64_tr_b16 v[16:17], v68 offset:80
    ds_read_b64_tr_b16 v[18:19], v68 offset:1360
    v_mfma_f32_32x32x16_bf16 v[144:159], v[48:51], v[56:59], v[144:159]
    ds_read_b64_tr_b16 v[20:21], v68 offset:120
    ds_read_b64_tr_b16 v[22:23], v68 offset:1400
    v_mfma_f32_32x32x16_bf16 v[224:239], v[48:51], v[60:63], v[224:239]
    ds_read_b64_tr_b16 v[24:25], v69 offset:0
    ds_read_b64_tr_b16 v[26:27], v69 offset:1280
    v_mfma_f32_32x32x16_bf16 v[160:175], v[52:55], v[56:59], v[160:175]
    v_mfma_f32_32x32x16_bf16 v[240:255], v[52:55], v[60:63], v[240:255]
    s_add_u32 s47, s47, 1
    s_cmp_lt_u32 s47, 10
    s_cbranch_scc1 gated_mix__mha_block__glu_gated_geglu__prompt_kernel_loop_qk
    s_waitcnt lgkmcnt(0)
    s_nop 15
    v_lshlrev_b32 v8, 4, v2
    s_and_b32 s23, s21, 3
    s_cmp_eq_u32 s29, 0
    s_cbranch_scc0 gated_mix__mha_block__glu_gated_geglu__prompt_kernel_kparams
    s_mov_b32 s62, 81920
    s_mul_i32 s61, s23, 655360
    s_lshl_b32 s24, s20, 3
    s_lshl_b32 s25, s22, 1
    s_add_u32 s24, s24, s25
    s_mul_i32 s24, s24, 1280
    s_add_u32 s61, s61, s24
    s_mov_b32 s60, 0x3ea52b5c
    s_branch gated_mix__mha_block__glu_gated_geglu__prompt_kernel_qk_go
gated_mix__mha_block__glu_gated_geglu__prompt_kernel_kparams:
    s_mov_b32 s62, 212992
    s_mul_i32 s61, s23, 1703936
    s_lshl_b32 s24, s20, 1
    s_lshr_b32 s25, s22, 1
    s_add_u32 s24, s24, s25
    s_mul_i32 s24, s24, 13312
    s_add_u32 s61, s61, s24
    s_and_b32 s25, s22, 1
    s_mul_i32 s25, s25, 2560
    s_add_u32 s61, s61, s25
    s_add_u32 s61, s61, 2621440
    s_mov_b32 s60, 1.0
gated_mix__mha_block__glu_gated_geglu__prompt_kernel_qk_go:
    s_mov_b32 s52, s61
    s_add_u32 s53, s52, s62
    s_add_u32 s54, s53, s62
    s_add_u32 s55, s54, s62
    s_add_u32 s56, s55, s62
    s_add_u32 s57, s56, s62
    s_add_u32 s58, s57, s62
    s_add_u32 s59, s58, s62
    v_and_b32 v3, 31, v2
    v_lshrrev_b32 v4, 5, v2
    v_mul_lo_u32 v4, v4, s62
    v_lshl_add_u32 v4, v3, 3, v4
    v_add_u32 v9, 1024, v4
    v_mov_b32 v10, s60
    v_mov_b32 v11, s60
    v_pk_mul_f32 v[96:97], v[96:97], v[10:11]
    v_pk_mul_f32 v[98:99], v[98:99], v[10:11]
    v_pk_mul_f32 v[100:101], v[100:101], v[10:11]
    v_pk_mul_f32 v[102:103], v[102:103], v[10:11]
    v_cvt_pk_bf16_f32 v16, v96, v97
    v_cvt_pk_bf16_f32 v17, v98, v99
    v_cvt_pk_bf16_f32 v18, v100, v101
    v_cvt_pk_bf16_f32 v19, v102, v103
    s_nop 1
    v_permlane32_swap_b32 v16, v18
    v_permlane32_swap_b32 v17, v19
    buffer_store_dwordx4 v[16:19], v8, s[40:43], s52 offen offset:0 sc1
    v_pk_mul_f32 v[104:105], v[104:105], v[10:11]
    v_pk_mul_f32 v[106:107], v[106:107], v[10:11]
    v_pk_mul_f32 v[108:109], v[108:109], v[10:11]
    v_pk_mul_f32 v[110:111], v[110:111], v[10:11]
    v_cvt_pk_bf16_f32 v20, v104, v105
    v_cvt_pk_bf16_f32 v21, v106, v107
    v_cvt_pk_bf16_f32 v22, v108, v109
    v_cvt_pk_bf16_f32 v23, v110, v111
    s_nop 1
    v_permlane32_swap_b32 v20, v22
    v_permlane32_swap_b32 v21, v23
    buffer_store_dwordx4 v[20:23], v8, s[40:43], s56 offen offset:0 sc1
    v_pk_mul_f32 v[176:177], v[176:177], v[10:11]
    v_pk_mul_f32 v[178:179], v[178:179], v[10:11]
    v_pk_mul_f32 v[180:181], v[180:181], v[10:11]
    v_pk_mul_f32 v[182:183], v[182:183], v[10:11]
    v_cvt_pk_bf16_f32 v24, v176, v177
    v_cvt_pk_bf16_f32 v25, v178, v179
    v_cvt_pk_bf16_f32 v26, v180, v181
    v_cvt_pk_bf16_f32 v27, v182, v183
    s_nop 1
    v_permlane32_swap_b32 v24, v26
    v_permlane32_swap_b32 v25, v27
    buffer_store_dwordx4 v[24:27], v8, s[40:43], s52 offen offset:1280 sc1
    v_pk_mul_f32 v[184:185], v[184:185], v[10:11]
    v_pk_mul_f32 v[186:187], v[186:187], v[10:11]
    v_pk_mul_f32 v[188:189], v[188:189], v[10:11]
    v_pk_mul_f32 v[190:191], v[190:191], v[10:11]
    v_cvt_pk_bf16_f32 v28, v184, v185
    v_cvt_pk_bf16_f32 v29, v186, v187
    v_cvt_pk_bf16_f32 v30, v188, v189
    v_cvt_pk_bf16_f32 v31, v190, v191
    s_nop 1
    v_permlane32_swap_b32 v28, v30
    v_permlane32_swap_b32 v29, v31
    buffer_store_dwordx4 v[28:31], v8, s[40:43], s56 offen offset:1280 sc1
    v_pk_mul_f32 v[112:113], v[112:113], v[10:11]
    v_pk_mul_f32 v[114:115], v[114:115], v[10:11]
    v_pk_mul_f32 v[116:117], v[116:117], v[10:11]
    v_pk_mul_f32 v[118:119], v[118:119], v[10:11]
    v_cvt_pk_bf16_f32 v32, v112, v113
    v_cvt_pk_bf16_f32 v33, v114, v115
    v_cvt_pk_bf16_f32 v34, v116, v117
    v_cvt_pk_bf16_f32 v35, v118, v119
    s_nop 1
    v_permlane32_swap_b32 v32, v34
    v_permlane32_swap_b32 v33, v35
    buffer_store_dwordx4 v[32:35], v8, s[40:43], s53 offen offset:0 sc1
    v_pk_mul_f32 v[120:121], v[120:121], v[10:11]
    v_pk_mul_f32 v[122:123], v[122:123], v[10:11]
    v_pk_mul_f32 v[124:125], v[124:125], v[10:11]
    v_pk_mul_f32 v[126:127], v[126:127], v[10:11]
    v_cvt_pk_bf16_f32 v36, v120, v121
    v_cvt_pk_bf16_f32 v37, v122, v123
    v_cvt_pk_bf16_f32 v38, v124, v125
    v_cvt_pk_bf16_f32 v39, v126, v127
    s_nop 1
    v_permlane32_swap_b32 v36, v38
    v_permlane32_swap_b32 v37, v39
    buffer_store_dwordx4 v[36:39], v8, s[40:43], s57 offen offset:0 sc1
    v_pk_mul_f32 v[192:193], v[192:193], v[10:11]
    v_pk_mul_f32 v[194:195], v[194:195], v[10:11]
    v_pk_mul_f32 v[196:197], v[196:197], v[10:11]
    v_pk_mul_f32 v[198:199], v[198:199], v[10:11]
    v_cvt_pk_bf16_f32 v40, v192, v193
    v_cvt_pk_bf16_f32 v41, v194, v195
    v_cvt_pk_bf16_f32 v42, v196, v197
    v_cvt_pk_bf16_f32 v43, v198, v199
    s_nop 1
    v_permlane32_swap_b32 v40, v42
    v_permlane32_swap_b32 v41, v43
    buffer_store_dwordx4 v[40:43], v8, s[40:43], s53 offen offset:1280 sc1
    v_pk_mul_f32 v[200:201], v[200:201], v[10:11]
    v_pk_mul_f32 v[202:203], v[202:203], v[10:11]
    v_pk_mul_f32 v[204:205], v[204:205], v[10:11]
    v_pk_mul_f32 v[206:207], v[206:207], v[10:11]
    v_cvt_pk_bf16_f32 v44, v200, v201
    v_cvt_pk_bf16_f32 v45, v202, v203
    v_cvt_pk_bf16_f32 v46, v204, v205
    v_cvt_pk_bf16_f32 v47, v206, v207
    s_nop 1
    v_permlane32_swap_b32 v44, v46
    v_permlane32_swap_b32 v45, v47
    buffer_store_dwordx4 v[44:47], v8, s[40:43], s57 offen offset:1280 sc1
    v_pk_mul_f32 v[128:129], v[128:129], v[10:11]
    v_pk_mul_f32 v[130:131], v[130:131], v[10:11]
    v_pk_mul_f32 v[132:133], v[132:133], v[10:11]
    v_pk_mul_f32 v[134:135], v[134:135], v[10:11]
    v_cvt_pk_bf16_f32 v16, v128, v129
    v_cvt_pk_bf16_f32 v17, v130, v131
    v_cvt_pk_bf16_f32 v18, v132, v133
    v_cvt_pk_bf16_f32 v19, v134, v135
    s_nop 1
    v_permlane32_swap_b32 v16, v18
    v_permlane32_swap_b32 v17, v19
    buffer_store_dwordx4 v[16:19], v8, s[40:43], s54 offen offset:0 sc1
    v_pk_mul_f32 v[136:137], v[136:137], v[10:11]
    v_pk_mul_f32 v[138:139], v[138:139], v[10:11]
    v_pk_mul_f32 v[140:141], v[140:141], v[10:11]
    v_pk_mul_f32 v[142:143], v[142:143], v[10:11]
    v_cvt_pk_bf16_f32 v20, v136, v137
    v_cvt_pk_bf16_f32 v21, v138, v139
    v_cvt_pk_bf16_f32 v22, v140, v141
    v_cvt_pk_bf16_f32 v23, v142, v143
    s_nop 1
    v_permlane32_swap_b32 v20, v22
    v_permlane32_swap_b32 v21, v23
    buffer_store_dwordx4 v[20:23], v8, s[40:43], s58 offen offset:0 sc1
    v_pk_mul_f32 v[208:209], v[208:209], v[10:11]
    v_pk_mul_f32 v[210:211], v[210:211], v[10:11]
    v_pk_mul_f32 v[212:213], v[212:213], v[10:11]
    v_pk_mul_f32 v[214:215], v[214:215], v[10:11]
    v_cvt_pk_bf16_f32 v24, v208, v209
    v_cvt_pk_bf16_f32 v25, v210, v211
    v_cvt_pk_bf16_f32 v26, v212, v213
    v_cvt_pk_bf16_f32 v27, v214, v215
    s_nop 1
    v_permlane32_swap_b32 v24, v26
    v_permlane32_swap_b32 v25, v27
    buffer_store_dwordx4 v[24:27], v8, s[40:43], s54 offen offset:1280 sc1
    v_pk_mul_f32 v[216:217], v[216:217], v[10:11]
    v_pk_mul_f32 v[218:219], v[218:219], v[10:11]
    v_pk_mul_f32 v[220:221], v[220:221], v[10:11]
    v_pk_mul_f32 v[222:223], v[222:223], v[10:11]
    v_cvt_pk_bf16_f32 v28, v216, v217
    v_cvt_pk_bf16_f32 v29, v218, v219
    v_cvt_pk_bf16_f32 v30, v220, v221
    v_cvt_pk_bf16_f32 v31, v222, v223
    s_nop 1
    v_permlane32_swap_b32 v28, v30
    v_permlane32_swap_b32 v29, v31
    buffer_store_dwordx4 v[28:31], v8, s[40:43], s58 offen offset:1280 sc1
    v_pk_mul_f32 v[144:145], v[144:145], v[10:11]
    v_pk_mul_f32 v[146:147], v[146:147], v[10:11]
    v_pk_mul_f32 v[148:149], v[148:149], v[10:11]
    v_pk_mul_f32 v[150:151], v[150:151], v[10:11]
    v_cvt_pk_bf16_f32 v32, v144, v145
    v_cvt_pk_bf16_f32 v33, v146, v147
    v_cvt_pk_bf16_f32 v34, v148, v149
    v_cvt_pk_bf16_f32 v35, v150, v151
    s_nop 1
    v_permlane32_swap_b32 v32, v34
    v_permlane32_swap_b32 v33, v35
    buffer_store_dwordx4 v[32:35], v8, s[40:43], s55 offen offset:0 sc1
    v_pk_mul_f32 v[152:153], v[152:153], v[10:11]
    v_pk_mul_f32 v[154:155], v[154:155], v[10:11]
    v_pk_mul_f32 v[156:157], v[156:157], v[10:11]
    v_pk_mul_f32 v[158:159], v[158:159], v[10:11]
    v_cvt_pk_bf16_f32 v36, v152, v153
    v_cvt_pk_bf16_f32 v37, v154, v155
    v_cvt_pk_bf16_f32 v38, v156, v157
    v_cvt_pk_bf16_f32 v39, v158, v159
    s_nop 1
    v_permlane32_swap_b32 v36, v38
    v_permlane32_swap_b32 v37, v39
    buffer_store_dwordx4 v[36:39], v8, s[40:43], s59 offen offset:0 sc1
    v_pk_mul_f32 v[224:225], v[224:225], v[10:11]
    v_pk_mul_f32 v[226:227], v[226:227], v[10:11]
    v_pk_mul_f32 v[228:229], v[228:229], v[10:11]
    v_pk_mul_f32 v[230:231], v[230:231], v[10:11]
    v_cvt_pk_bf16_f32 v40, v224, v225
    v_cvt_pk_bf16_f32 v41, v226, v227
    v_cvt_pk_bf16_f32 v42, v228, v229
    v_cvt_pk_bf16_f32 v43, v230, v231
    s_nop 1
    v_permlane32_swap_b32 v40, v42
    v_permlane32_swap_b32 v41, v43
    buffer_store_dwordx4 v[40:43], v8, s[40:43], s55 offen offset:1280 sc1
    v_pk_mul_f32 v[232:233], v[232:233], v[10:11]
    v_pk_mul_f32 v[234:235], v[234:235], v[10:11]
    v_pk_mul_f32 v[236:237], v[236:237], v[10:11]
    v_pk_mul_f32 v[238:239], v[238:239], v[10:11]
    v_cvt_pk_bf16_f32 v44, v232, v233
    v_cvt_pk_bf16_f32 v45, v234, v235
    v_cvt_pk_bf16_f32 v46, v236, v237
    v_cvt_pk_bf16_f32 v47, v238, v239
    s_nop 1
    v_permlane32_swap_b32 v44, v46
    v_permlane32_swap_b32 v45, v47
    buffer_store_dwordx4 v[44:47], v8, s[40:43], s59 offen offset:1280 sc1
    v_pk_mul_f32 v[160:161], v[160:161], v[10:11]
    v_pk_mul_f32 v[162:163], v[162:163], v[10:11]
    v_cvt_pk_bf16_f32 v16, v160, v161
    v_cvt_pk_bf16_f32 v17, v162, v163
    buffer_store_dwordx2 v[16:17], v9, s[40:43], s52 offen offset:0 sc1
    v_pk_mul_f32 v[164:165], v[164:165], v[10:11]
    v_pk_mul_f32 v[166:167], v[166:167], v[10:11]
    v_cvt_pk_bf16_f32 v20, v164, v165
    v_cvt_pk_bf16_f32 v21, v166, v167
    buffer_store_dwordx2 v[20:21], v9, s[40:43], s54 offen offset:0 sc1
    v_pk_mul_f32 v[168:169], v[168:169], v[10:11]
    v_pk_mul_f32 v[170:171], v[170:171], v[10:11]
    v_cvt_pk_bf16_f32 v24, v168, v169
    v_cvt_pk_bf16_f32 v25, v170, v171
    buffer_store_dwordx2 v[24:25], v9, s[40:43], s56 offen offset:0 sc1
    v_pk_mul_f32 v[172:173], v[172:173], v[10:11]
    v_pk_mul_f32 v[174:175], v[174:175], v[10:11]
    v_cvt_pk_bf16_f32 v28, v172, v173
    v_cvt_pk_bf16_f32 v29, v174, v175
    buffer_store_dwordx2 v[28:29], v9, s[40:43], s58 offen offset:0 sc1
    v_pk_mul_f32 v[240:241], v[240:241], v[10:11]
    v_pk_mul_f32 v[242:243], v[242:243], v[10:11]
    v_cvt_pk_bf16_f32 v32, v240, v241
    v_cvt_pk_bf16_f32 v33, v242, v243
    buffer_store_dwordx2 v[32:33], v9, s[40:43], s52 offen offset:1280 sc1
    v_pk_mul_f32 v[244:245], v[244:245], v[10:11]
    v_pk_mul_f32 v[246:247], v[246:247], v[10:11]
    v_cvt_pk_bf16_f32 v36, v244, v245
    v_cvt_pk_bf16_f32 v37, v246, v247
    buffer_store_dwordx2 v[36:37], v9, s[40:43], s54 offen offset:1280 sc1
    v_pk_mul_f32 v[248:249], v[248:249], v[10:11]
    v_pk_mul_f32 v[250:251], v[250:251], v[10:11]
    v_cvt_pk_bf16_f32 v40, v248, v249
    v_cvt_pk_bf16_f32 v41, v250, v251
    buffer_store_dwordx2 v[40:41], v9, s[40:43], s56 offen offset:1280 sc1
    v_pk_mul_f32 v[252:253], v[252:253], v[10:11]
    v_pk_mul_f32 v[254:255], v[254:255], v[10:11]
    v_cvt_pk_bf16_f32 v44, v252, v253
    v_cvt_pk_bf16_f32 v45, v254, v255
    buffer_store_dwordx2 v[44:45], v9, s[40:43], s58 offen offset:1280 sc1
    s_branch gated_mix__mha_block__glu_gated_geglu__prompt_kernel_fin
gated_mix__mha_block__glu_gated_geglu__prompt_kernel_vblock:
    s_waitcnt vmcnt(8)
    s_barrier
    ds_read_b128 v[28:31], v64 offset:0
    ds_read_b64_tr_b16 v[8:9], v68 offset:0
    ds_read_b64_tr_b16 v[10:11], v68 offset:1280
    ds_read_b128 v[32:35], v64 offset:4096
    ds_read_b64_tr_b16 v[12:13], v68 offset:40
    ds_read_b64_tr_b16 v[14:15], v68 offset:1320
    ds_read_b64_tr_b16 v[16:17], v68 offset:80
    ds_read_b64_tr_b16 v[18:19], v68 offset:1360
    ds_read_b64_tr_b16 v[20:21], v68 offset:120
    ds_read_b64_tr_b16 v[22:23], v68 offset:1400
    ds_read_b64_tr_b16 v[24:25], v69 offset:0
    ds_read_b64_tr_b16 v[26:27], v69 offset:1280
    s_mov_b32 s47, 0
    s_mov_b32 s44, 0
    s_mov_b32 s84, 53376
    s_mov_b32 s85, 4294860544
.p2align 6
gated_mix__mha_block__glu_gated_geglu__prompt_kernel_loop_v:
    s_waitcnt lgkmcnt(8)
    v_mfma_f32_32x32x16_bf16 v[96:111], v[28:31], v[8:11], v[96:111]
    ds_read_b128 v[56:59], v65 offset:0
    ds_read_b64_tr_b16 v[36:37], v68 offset:5120
    v_mfma_f32_32x32x16_bf16 v[176:191], v[32:35], v[8:11], v[176:191]
    ds_read_b64_tr_b16 v[38:39], v68 offset:6400
    ds_read_b128 v[60:63], v65 offset:4096
    s_waitcnt lgkmcnt(10)
    v_mfma_f32_32x32x16_bf16 v[112:127], v[28:31], v[12:15], v[112:127]
    ds_read_b64_tr_b16 v[40:41], v68 offset:5160
    ds_read_b64_tr_b16 v[42:43], v68 offset:6440
    v_mfma_f32_32x32x16_bf16 v[192:207], v[32:35], v[12:15], v[192:207]
    ds_read_b64_tr_b16 v[44:45], v68 offset:5200
    ds_read_b64_tr_b16 v[46:47], v68 offset:6480
    s_waitcnt lgkmcnt(12)
    v_mfma_f32_32x32x16_bf16 v[128:143], v[28:31], v[16:19], v[128:143]
    ds_read_b64_tr_b16 v[48:49], v68 offset:5240
    ds_read_b64_tr_b16 v[50:51], v68 offset:6520
    v_mfma_f32_32x32x16_bf16 v[208:223], v[32:35], v[16:19], v[208:223]
    ds_read_b64_tr_b16 v[52:53], v69 offset:5120
    ds_read_b64_tr_b16 v[54:55], v69 offset:6400
    s_waitcnt lgkmcnt(14)
    v_mfma_f32_32x32x16_bf16 v[144:159], v[28:31], v[20:23], v[144:159]
    v_mfma_f32_32x32x16_bf16 v[224:239], v[32:35], v[20:23], v[224:239]
    s_waitcnt lgkmcnt(12)
    v_mfma_f32_32x32x16_bf16 v[160:175], v[28:31], v[24:27], v[160:175]
    v_mfma_f32_32x32x16_bf16 v[240:255], v[32:35], v[24:27], v[240:255]
    s_waitcnt lgkmcnt(8)
    v_mfma_f32_32x32x16_bf16 v[96:111], v[56:59], v[36:39], v[96:111]
    ds_read_b128 v[28:31], v66 offset:0
    ds_read_b64_tr_b16 v[8:9], v68 offset:10240
    v_mfma_f32_32x32x16_bf16 v[176:191], v[60:63], v[36:39], v[176:191]
    ds_read_b64_tr_b16 v[10:11], v68 offset:11520
    ds_read_b128 v[32:35], v66 offset:4096
    s_waitcnt lgkmcnt(10)
    v_mfma_f32_32x32x16_bf16 v[112:127], v[56:59], v[40:43], v[112:127]
    ds_read_b64_tr_b16 v[12:13], v68 offset:10280
    ds_read_b64_tr_b16 v[14:15], v68 offset:11560
    v_mfma_f32_32x32x16_bf16 v[192:207], v[60:63], v[40:43], v[192:207]
    ds_read_b64_tr_b16 v[16:17], v68 offset:10320
    ds_read_b64_tr_b16 v[18:19], v68 offset:11600
    s_waitcnt lgkmcnt(12)
    v_mfma_f32_32x32x16_bf16 v[128:143], v[56:59], v[44:47], v[128:143]
    ds_read_b64_tr_b16 v[20:21], v68 offset:10360
    ds_read_b64_tr_b16 v[22:23], v68 offset:11640
    v_mfma_f32_32x32x16_bf16 v[208:223], v[60:63], v[44:47], v[208:223]
    ds_read_b64_tr_b16 v[24:25], v69 offset:10240
    ds_read_b64_tr_b16 v[26:27], v69 offset:11520
    s_waitcnt lgkmcnt(14)
    v_mfma_f32_32x32x16_bf16 v[144:159], v[56:59], v[48:51], v[144:159]
    v_mfma_f32_32x32x16_bf16 v[224:239], v[60:63], v[48:51], v[224:239]
    s_waitcnt lgkmcnt(12)
    v_mfma_f32_32x32x16_bf16 v[160:175], v[56:59], v[52:55], v[160:175]
    v_mfma_f32_32x32x16_bf16 v[240:255], v[60:63], v[52:55], v[240:255]
    s_waitcnt lgkmcnt(8)
    v_mfma_f32_32x32x16_bf16 v[96:111], v[28:31], v[8:11], v[96:111]
    ds_read_b128 v[56:59], v67 offset:0
    ds_read_b64_tr_b16 v[36:37], v68 offset:15360
    v_mfma_f32_32x32x16_bf16 v[176:191], v[32:35], v[8:11], v[176:191]
    ds_read_b64_tr_b16 v[38:39], v68 offset:16640
    ds_read_b128 v[60:63], v67 offset:4096
    s_waitcnt lgkmcnt(10)
    v_mfma_f32_32x32x16_bf16 v[112:127], v[28:31], v[12:15], v[112:127]
    ds_read_b64_tr_b16 v[40:41], v68 offset:15400
    ds_read_b64_tr_b16 v[42:43], v68 offset:16680
    v_mfma_f32_32x32x16_bf16 v[192:207], v[32:35], v[12:15], v[192:207]
    ds_read_b64_tr_b16 v[44:45], v68 offset:15440
    ds_read_b64_tr_b16 v[46:47], v68 offset:16720
    s_waitcnt lgkmcnt(12)
    v_mfma_f32_32x32x16_bf16 v[128:143], v[28:31], v[16:19], v[128:143]
    ds_read_b64_tr_b16 v[48:49], v68 offset:15480
    ds_read_b64_tr_b16 v[50:51], v68 offset:16760
    v_mfma_f32_32x32x16_bf16 v[208:223], v[32:35], v[16:19], v[208:223]
    ds_read_b64_tr_b16 v[52:53], v69 offset:15360
    ds_read_b64_tr_b16 v[54:55], v69 offset:16640
    s_waitcnt lgkmcnt(14)
    v_mfma_f32_32x32x16_bf16 v[144:159], v[28:31], v[20:23], v[144:159]
    v_mfma_f32_32x32x16_bf16 v[224:239], v[32:35], v[20:23], v[224:239]
    s_waitcnt lgkmcnt(12)
    v_mfma_f32_32x32x16_bf16 v[160:175], v[28:31], v[24:27], v[160:175]
    v_mfma_f32_32x32x16_bf16 v[240:255], v[32:35], v[24:27], v[240:255]
    s_waitcnt lgkmcnt(8)
    v_mfma_f32_32x32x16_bf16 v[96:111], v[56:59], v[36:39], v[96:111]
    v_mfma_f32_32x32x16_bf16 v[176:191], v[60:63], v[36:39], v[176:191]
    s_waitcnt lgkmcnt(0)
    s_add_u32 s44, s44, 1
    s_cmp_eq_u32 s44, 3
    s_cselect_b32 s23, s85, s84
    s_cselect_b32 s44, 0, s44
    s_cmp_eq_u32 s47, 0
    s_cbranch_scc0 gated_mix__mha_block__glu_gated_geglu__prompt_kernel_nw_v
    s_waitcnt vmcnt(0)
gated_mix__mha_block__glu_gated_geglu__prompt_kernel_nw_v:
    s_barrier
    v_add_u32 v64, s23, v64
    v_add_u32 v65, s23, v65
    v_add_u32 v66, s23, v66
    v_add_u32 v67, s23, v67
    v_add_u32 v68, s23, v68
    v_add_u32 v69, s23, v69
    v_mfma_f32_32x32x16_bf16 v[112:127], v[56:59], v[40:43], v[112:127]
    ds_read_b128 v[28:31], v64 offset:0
    ds_read_b64_tr_b16 v[8:9], v68 offset:0
    v_mfma_f32_32x32x16_bf16 v[192:207], v[60:63], v[40:43], v[192:207]
    ds_read_b64_tr_b16 v[10:11], v68 offset:1280
    ds_read_b128 v[32:35], v64 offset:4096
    v_mfma_f32_32x32x16_bf16 v[128:143], v[56:59], v[44:47], v[128:143]
    ds_read_b64_tr_b16 v[12:13], v68 offset:40
    ds_read_b64_tr_b16 v[14:15], v68 offset:1320
    v_mfma_f32_32x32x16_bf16 v[208:223], v[60:63], v[44:47], v[208:223]
    ds_read_b64_tr_b16 v[16:17], v68 offset:80
    ds_read_b64_tr_b16 v[18:19], v68 offset:1360
    v_mfma_f32_32x32x16_bf16 v[144:159], v[56:59], v[48:51], v[144:159]
    ds_read_b64_tr_b16 v[20:21], v68 offset:120
    ds_read_b64_tr_b16 v[22:23], v68 offset:1400
    v_mfma_f32_32x32x16_bf16 v[224:239], v[60:63], v[48:51], v[224:239]
    ds_read_b64_tr_b16 v[24:25], v69 offset:0
    ds_read_b64_tr_b16 v[26:27], v69 offset:1280
    v_mfma_f32_32x32x16_bf16 v[160:175], v[56:59], v[52:55], v[160:175]
    v_mfma_f32_32x32x16_bf16 v[240:255], v[60:63], v[52:55], v[240:255]
    s_add_u32 s47, s47, 1
    s_cmp_lt_u32 s47, 10
    s_cbranch_scc1 gated_mix__mha_block__glu_gated_geglu__prompt_kernel_loop_v
    s_waitcnt lgkmcnt(0)
    s_nop 15
    s_mov_b32 s62, 212992
    v_bfe_u32 v5, v2, 4, 1
    v_lshlrev_b32 v5, 2, v5
    v_lshrrev_b32 v4, 5, v2
    v_lshlrev_b32 v4, 9, v4
    v_mul_lo_u32 v6, v5, s62
    v_and_b32 v3, 15, v2
    v_lshl_add_u32 v6, v3, 4, v6
    v_add_u32 v8, v6, v4
    v_bfe_u32 v6, v2, 2, 2
    v_add_u32 v6, v6, v5
    v_mul_lo_u32 v6, v6, s62
    v_and_b32 v3, 3, v2
    v_lshl_add_u32 v6, v3, 4, v6
    v_add3_u32 v9, v6, v4, 0
    v_add_u32 v9, 256, v9
    s_sub_u32 s23, s21, 8
    s_mul_i32 s61, s23, 1703936
    s_lshl_b32 s24, s20, 1
    s_lshr_b32 s25, s22, 1
    s_add_u32 s24, s24, s25
    s_mul_i32 s24, s24, 13312
    s_add_u32 s61, s61, s24
    s_and_b32 s25, s22, 1
    s_lshl_b32 s25, s25, 12
    s_add_u32 s61, s61, s25
    s_add_u32 s61, s61, 2626560
    v_cvt_pk_bf16_f32 v16, v96, v97
    v_cvt_pk_bf16_f32 v17, v98, v99
    v_cvt_pk_bf16_f32 v18, v100, v101
    v_cvt_pk_bf16_f32 v19, v102, v103
    buffer_store_dwordx4 v[16:19], v8, s[40:43], s61 offen offset:0 sc1
    v_cvt_pk_bf16_f32 v20, v104, v105
    v_cvt_pk_bf16_f32 v21, v106, v107
    v_cvt_pk_bf16_f32 v22, v108, v109
    v_cvt_pk_bf16_f32 v23, v110, v111
    buffer_store_dwordx4 v[20:23], v8, s[40:43], s61 offen offset:1024 sc1
    v_cvt_pk_bf16_f32 v24, v176, v177
    v_cvt_pk_bf16_f32 v25, v178, v179
    v_cvt_pk_bf16_f32 v26, v180, v181
    v_cvt_pk_bf16_f32 v27, v182, v183
    buffer_store_dwordx4 v[24:27], v8, s[40:43], s61 offen offset:2048 sc1
    v_cvt_pk_bf16_f32 v28, v184, v185
    v_cvt_pk_bf16_f32 v29, v186, v187
    v_cvt_pk_bf16_f32 v30, v188, v189
    v_cvt_pk_bf16_f32 v31, v190, v191
    buffer_store_dwordx4 v[28:31], v8, s[40:43], s61 offen offset:3072 sc1
    s_add_u32 s61, s61, s62
    v_cvt_pk_bf16_f32 v32, v112, v113
    v_cvt_pk_bf16_f32 v33, v114, v115
    v_cvt_pk_bf16_f32 v34, v116, v117
    v_cvt_pk_bf16_f32 v35, v118, v119
    buffer_store_dwordx4 v[32:35], v8, s[40:43], s61 offen offset:0 sc1
    v_cvt_pk_bf16_f32 v36, v120, v121
    v_cvt_pk_bf16_f32 v37, v122, v123
    v_cvt_pk_bf16_f32 v38, v124, v125
    v_cvt_pk_bf16_f32 v39, v126, v127
    buffer_store_dwordx4 v[36:39], v8, s[40:43], s61 offen offset:1024 sc1
    v_cvt_pk_bf16_f32 v40, v192, v193
    v_cvt_pk_bf16_f32 v41, v194, v195
    v_cvt_pk_bf16_f32 v42, v196, v197
    v_cvt_pk_bf16_f32 v43, v198, v199
    buffer_store_dwordx4 v[40:43], v8, s[40:43], s61 offen offset:2048 sc1
    v_cvt_pk_bf16_f32 v44, v200, v201
    v_cvt_pk_bf16_f32 v45, v202, v203
    v_cvt_pk_bf16_f32 v46, v204, v205
    v_cvt_pk_bf16_f32 v47, v206, v207
    buffer_store_dwordx4 v[44:47], v8, s[40:43], s61 offen offset:3072 sc1
    s_add_u32 s61, s61, s62
    v_cvt_pk_bf16_f32 v16, v128, v129
    v_cvt_pk_bf16_f32 v17, v130, v131
    v_cvt_pk_bf16_f32 v18, v132, v133
    v_cvt_pk_bf16_f32 v19, v134, v135
    buffer_store_dwordx4 v[16:19], v8, s[40:43], s61 offen offset:0 sc1
    v_cvt_pk_bf16_f32 v20, v136, v137
    v_cvt_pk_bf16_f32 v21, v138, v139
    v_cvt_pk_bf16_f32 v22, v140, v141
    v_cvt_pk_bf16_f32 v23, v142, v143
    buffer_store_dwordx4 v[20:23], v8, s[40:43], s61 offen offset:1024 sc1
    v_cvt_pk_bf16_f32 v24, v208, v209
    v_cvt_pk_bf16_f32 v25, v210, v211
    v_cvt_pk_bf16_f32 v26, v212, v213
    v_cvt_pk_bf16_f32 v27, v214, v215
    buffer_store_dwordx4 v[24:27], v8, s[40:43], s61 offen offset:2048 sc1
    v_cvt_pk_bf16_f32 v28, v216, v217
    v_cvt_pk_bf16_f32 v29, v218, v219
    v_cvt_pk_bf16_f32 v30, v220, v221
    v_cvt_pk_bf16_f32 v31, v222, v223
    buffer_store_dwordx4 v[28:31], v8, s[40:43], s61 offen offset:3072 sc1
    s_add_u32 s61, s61, s62
    v_cvt_pk_bf16_f32 v32, v144, v145
    v_cvt_pk_bf16_f32 v33, v146, v147
    v_cvt_pk_bf16_f32 v34, v148, v149
    v_cvt_pk_bf16_f32 v35, v150, v151
    buffer_store_dwordx4 v[32:35], v8, s[40:43], s61 offen offset:0 sc1
    v_cvt_pk_bf16_f32 v36, v152, v153
    v_cvt_pk_bf16_f32 v37, v154, v155
    v_cvt_pk_bf16_f32 v38, v156, v157
    v_cvt_pk_bf16_f32 v39, v158, v159
    buffer_store_dwordx4 v[36:39], v8, s[40:43], s61 offen offset:1024 sc1
    v_cvt_pk_bf16_f32 v40, v224, v225
    v_cvt_pk_bf16_f32 v41, v226, v227
    v_cvt_pk_bf16_f32 v42, v228, v229
    v_cvt_pk_bf16_f32 v43, v230, v231
    buffer_store_dwordx4 v[40:43], v8, s[40:43], s61 offen offset:2048 sc1
    v_cvt_pk_bf16_f32 v44, v232, v233
    v_cvt_pk_bf16_f32 v45, v234, v235
    v_cvt_pk_bf16_f32 v46, v236, v237
    v_cvt_pk_bf16_f32 v47, v238, v239
    buffer_store_dwordx4 v[44:47], v8, s[40:43], s61 offen offset:3072 sc1
    s_sub_u32 s61, s61, 638976
    v_cvt_pk_bf16_f32 v16, v160, v161
    v_cvt_pk_bf16_f32 v17, v162, v163
    v_cvt_pk_bf16_f32 v18, v164, v165
    v_cvt_pk_bf16_f32 v19, v166, v167
    buffer_store_dwordx4 v[16:19], v9, s[40:43], s61 offen offset:0 sc1
    v_cvt_pk_bf16_f32 v20, v168, v169
    v_cvt_pk_bf16_f32 v21, v170, v171
    v_cvt_pk_bf16_f32 v22, v172, v173
    v_cvt_pk_bf16_f32 v23, v174, v175
    buffer_store_dwordx4 v[20:23], v9, s[40:43], s61 offen offset:1024 sc1
    v_cvt_pk_bf16_f32 v24, v240, v241
    v_cvt_pk_bf16_f32 v25, v242, v243
    v_cvt_pk_bf16_f32 v26, v244, v245
    v_cvt_pk_bf16_f32 v27, v246, v247
    buffer_store_dwordx4 v[24:27], v9, s[40:43], s61 offen offset:2048 sc1
    v_cvt_pk_bf16_f32 v28, v248, v249
    v_cvt_pk_bf16_f32 v29, v250, v251
    v_cvt_pk_bf16_f32 v30, v252, v253
    v_cvt_pk_bf16_f32 v31, v254, v255
    buffer_store_dwordx4 v[28:31], v9, s[40:43], s61 offen offset:3072 sc1
    s_branch gated_mix__mha_block__glu_gated_geglu__prompt_kernel_fin
gated_mix__mha_block__glu_gated_geglu__prompt_kernel_f6c:
    v_lshrrev_b32 v3, 3, v2
    v_lshrrev_b32 v4, 4, v2
    v_and_b32 v5, 7, v2
    v_xor_b32 v5, v5, v4
    v_xor_b32 v6, 4, v5
    s_lshl_b32 s23, s22, 6
    v_add_u32 v3, s23, v3
    v_mul_u32_u24 v3, 1280, v3
    v_lshl_add_u32 v5, v5, 4, v3
    v_lshl_add_u32 v6, v6, 4, v3
    v_add_u32 v54, 0, v5
    v_add_u32 v55, 10240, v6
    v_add_u32 v56, 20480, v5
    v_add_u32 v57, 30720, v6
    v_add_u32 v58, 40960, v5
    v_add_u32 v59, 51200, v6
    v_add_u32 v60, 61440, v5
    v_add_u32 v61, 71680, v6
    s_mul_i32 s45, s20, 327680
    s_lshl_b32 s24, s22, 13
    s_waitcnt lgkmcnt(0)
    s_mov_b32 s32, s4
    s_and_b32 s33, s5, 0xffff
    s_mov_b32 s34, 2621440
    s_mov_b32 s35, 0x20000
    s_mov_b32 s40, s48
    s_and_b32 s41, s49, 0xffff
    s_mov_b32 s42, 26214400
    s_mov_b32 s43, 0x20000
    s_add_u32 m0, s24, 0
    s_nop 0
    buffer_load_dwordx4 v54, s[32:35], s45 offen lds
    s_add_u32 m0, s24, 1024
    s_nop 0
    buffer_load_dwordx4 v55, s[32:35], s45 offen lds
    s_add_u32 m0, s24, 2048
    s_nop 0
    buffer_load_dwordx4 v56, s[32:35], s45 offen lds
    s_add_u32 m0, s24, 3072
    s_nop 0
    buffer_load_dwordx4 v57, s[32:35], s45 offen lds
    s_add_u32 m0, s24, 4096
    s_nop 0
    buffer_load_dwordx4 v58, s[32:35], s45 offen lds
    s_add_u32 m0, s24, 5120
    s_nop 0
    buffer_load_dwordx4 v59, s[32:35], s45 offen lds
    s_add_u32 m0, s24, 6144
    s_nop 0
    buffer_load_dwordx4 v60, s[32:35], s45 offen lds
    s_add_u32 m0, s24, 7168
    s_nop 0
    buffer_load_dwordx4 v61, s[32:35], s45 offen lds
    s_add_u32 s45, s45, 128
    s_add_u32 m0, s24, 32768
    s_nop 0
    buffer_load_dwordx4 v54, s[32:35], s45 offen lds
    s_add_u32 m0, s24, 33792
    s_nop 0
    buffer_load_dwordx4 v55, s[32:35], s45 offen lds
    s_add_u32 m0, s24, 34816
    s_nop 0
    buffer_load_dwordx4 v56, s[32:35], s45 offen lds
    s_add_u32 m0, s24, 35840
    s_nop 0
    buffer_load_dwordx4 v57, s[32:35], s45 offen lds
    s_add_u32 m0, s24, 36864
    s_nop 0
    buffer_load_dwordx4 v58, s[32:35], s45 offen lds
    s_add_u32 m0, s24, 37888
    s_nop 0
    buffer_load_dwordx4 v59, s[32:35], s45 offen lds
    s_add_u32 m0, s24, 38912
    s_nop 0
    buffer_load_dwordx4 v60, s[32:35], s45 offen lds
    s_add_u32 m0, s24, 39936
    s_nop 0
    buffer_load_dwordx4 v61, s[32:35], s45 offen lds
    s_add_u32 s45, s45, 128
    v_and_b32 v3, 31, v2
    v_lshrrev_b32 v4, 5, v2
    s_lshl_b32 s23, s22, 6
    v_add_u32 v5, s23, v3
    v_lshlrev_b32 v5, 7, v5
    v_bfe_u32 v6, v3, 1, 3
    v_or_b32 v7, 0, v4
    v_xor_b32 v7, v7, v6
    v_lshl_add_u32 v48, v7, 4, v5
    v_or_b32 v7, 2, v4
    v_xor_b32 v7, v7, v6
    v_lshl_add_u32 v49, v7, 4, v5
    v_or_b32 v7, 4, v4
    v_xor_b32 v7, v7, v6
    v_lshl_add_u32 v50, v7, 4, v5
    v_or_b32 v7, 6, v4
    v_xor_b32 v7, v7, v6
    v_lshl_add_u32 v51, v7, 4, v5
    v_bfe_u32 v5, v2, 4, 1
    v_mul_u32_u24 v5, 6176, v5
    v_bfe_u32 v6, v2, 2, 2
    v_lshl_add_u32 v6, v4, 3, v6
    v_mul_u32_u24 v6, 192, v6
    v_and_b32 v7, 3, v2
    v_lshlrev_b32 v7, 3, v7
    v_add3_u32 v5, v5, v6, v7
    v_add_u32 v52, 98304, v5
    v_mov_b32 v64, 0
    v_mov_b32 v65, 0
    v_mov_b32 v66, 0
    v_mov_b32 v67, 0
    v_mov_b32 v68, 0
    v_mov_b32 v69, 0
    v_mov_b32 v70, 0
    v_mov_b32 v71, 0
    v_mov_b32 v72, 0
    v_mov_b32 v73, 0
    v_mov_b32 v74, 0
    v_mov_b32 v75, 0
    v_mov_b32 v76, 0
    v_mov_b32 v77, 0
    v_mov_b32 v78, 0
    v_mov_b32 v79, 0
    v_mov_b32 v80, 0
    v_mov_b32 v81, 0
    v_mov_b32 v82, 0
    v_mov_b32 v83, 0
    v_mov_b32 v84, 0
    v_mov_b32 v85, 0
    v_mov_b32 v86, 0
    v_mov_b32 v87, 0
    v_mov_b32 v88, 0
    v_mov_b32 v89, 0
    v_mov_b32 v90, 0
    v_mov_b32 v91, 0
    v_mov_b32 v92, 0
    v_mov_b32 v93, 0
    v_mov_b32 v94, 0
    v_mov_b32 v95, 0
    v_mov_b32 v96, 0
    v_mov_b32 v97, 0
    v_mov_b32 v98, 0
    v_mov_b32 v99, 0
    v_mov_b32 v100, 0
    v_mov_b32 v101, 0
    v_mov_b32 v102, 0
    v_mov_b32 v103, 0
    v_mov_b32 v104, 0
    v_mov_b32 v105, 0
    v_mov_b32 v106, 0
    v_mov_b32 v107, 0
    v_mov_b32 v108, 0
    v_mov_b32 v109, 0
    v_mov_b32 v110, 0
    v_mov_b32 v111, 0
    v_mov_b32 v112, 0
    v_mov_b32 v113, 0
    v_mov_b32 v114, 0
    v_mov_b32 v115, 0
    v_mov_b32 v116, 0
    v_mov_b32 v117, 0
    v_mov_b32 v118, 0
    v_mov_b32 v119, 0
    v_mov_b32 v120, 0
    v_mov_b32 v121, 0
    v_mov_b32 v122, 0
    v_mov_b32 v123, 0
    v_mov_b32 v124, 0
    v_mov_b32 v125, 0
    v_mov_b32 v126, 0
    v_mov_b32 v127, 0
    v_mov_b32 v128, 0
    v_mov_b32 v129, 0
    v_mov_b32 v130, 0
    v_mov_b32 v131, 0
    v_mov_b32 v132, 0
    v_mov_b32 v133, 0
    v_mov_b32 v134, 0
    v_mov_b32 v135, 0
    v_mov_b32 v136, 0
    v_mov_b32 v137, 0
    v_mov_b32 v138, 0
    v_mov_b32 v139, 0
    v_mov_b32 v140, 0
    v_mov_b32 v141, 0
    v_mov_b32 v142, 0
    v_mov_b32 v143, 0
    v_mov_b32 v144, 0
    v_mov_b32 v145, 0
    v_mov_b32 v146, 0
    v_mov_b32 v147, 0
    v_mov_b32 v148, 0
    v_mov_b32 v149, 0
    v_mov_b32 v150, 0
    v_mov_b32 v151, 0
    v_mov_b32 v152, 0
    v_mov_b32 v153, 0
    v_mov_b32 v154, 0
    v_mov_b32 v155, 0
    v_mov_b32 v156, 0
    v_mov_b32 v157, 0
    v_mov_b32 v158, 0
    v_mov_b32 v159, 0
    v_mov_b32 v160, 0
    v_mov_b32 v161, 0
    v_mov_b32 v162, 0
    v_mov_b32 v163, 0
    v_mov_b32 v164, 0
    v_mov_b32 v165, 0
    v_mov_b32 v166, 0
    v_mov_b32 v167, 0
    v_mov_b32 v168, 0
    v_mov_b32 v169, 0
    v_mov_b32 v170, 0
    v_mov_b32 v171, 0
    v_mov_b32 v172, 0
    v_mov_b32 v173, 0
    v_mov_b32 v174, 0
    v_mov_b32 v175, 0
    v_mov_b32 v176, 0
    v_mov_b32 v177, 0
    v_mov_b32 v178, 0
    v_mov_b32 v179, 0
    v_mov_b32 v180, 0
    v_mov_b32 v181, 0
    v_mov_b32 v182, 0
    v_mov_b32 v183, 0
    v_mov_b32 v184, 0
    v_mov_b32 v185, 0
    v_mov_b32 v186, 0
    v_mov_b32 v187, 0
    v_mov_b32 v188, 0
    v_mov_b32 v189, 0
    v_mov_b32 v190, 0
    v_mov_b32 v191, 0
    v_mov_b32 v192, 0
    v_mov_b32 v193, 0
    v_mov_b32 v194, 0
    v_mov_b32 v195, 0
    v_mov_b32 v196, 0
    v_mov_b32 v197, 0
    v_mov_b32 v198, 0
    v_mov_b32 v199, 0
    v_mov_b32 v200, 0
    v_mov_b32 v201, 0
    v_mov_b32 v202, 0
    v_mov_b32 v203, 0
    v_mov_b32 v204, 0
    v_mov_b32 v205, 0
    v_mov_b32 v206, 0
    v_mov_b32 v207, 0
    v_mov_b32 v208, 0
    v_mov_b32 v209, 0
    v_mov_b32 v210, 0
    v_mov_b32 v211, 0
    v_mov_b32 v212, 0
    v_mov_b32 v213, 0
    v_mov_b32 v214, 0
    v_mov_b32 v215, 0
    v_mov_b32 v216, 0
    v_mov_b32 v217, 0
    v_mov_b32 v218, 0
    v_mov_b32 v219, 0
    v_mov_b32 v220, 0
    v_mov_b32 v221, 0
    v_mov_b32 v222, 0
    v_mov_b32 v223, 0
    v_mov_b32 v224, 0
    v_mov_b32 v225, 0
    v_mov_b32 v226, 0
    v_mov_b32 v227, 0
    v_mov_b32 v228, 0
    v_mov_b32 v229, 0
    v_mov_b32 v230, 0
    v_mov_b32 v231, 0
    v_mov_b32 v232, 0
    v_mov_b32 v233, 0
    v_mov_b32 v234, 0
    v_mov_b32 v235, 0
    v_mov_b32 v236, 0
    v_mov_b32 v237, 0
    v_mov_b32 v238, 0
    v_mov_b32 v239, 0
    v_mov_b32 v240, 0
    v_mov_b32 v241, 0
    v_mov_b32 v242, 0
    v_mov_b32 v243, 0
    v_mov_b32 v244, 0
    v_mov_b32 v245, 0
    v_mov_b32 v246, 0
    v_mov_b32 v247, 0
    v_mov_b32 v248, 0
    v_mov_b32 v249, 0
    v_mov_b32 v250, 0
    v_mov_b32 v251, 0
    v_mov_b32 v252, 0
    v_mov_b32 v253, 0
    v_mov_b32 v254, 0
    v_mov_b32 v255, 0
    s_waitcnt vmcnt(8)
    s_barrier
    ds_read_b128 v[32:35], v48 offset:0
    ds_read_b128 v[36:39], v48 offset:4096
    ds_read_b64_tr_b16 v[8:9], v52 offset:0
    ds_read_b64_tr_b16 v[10:11], v52 offset:768
    ds_read_b64_tr_b16 v[12:13], v52 offset:32
    ds_read_b64_tr_b16 v[14:15], v52 offset:800
    ds_read_b64_tr_b16 v[16:17], v52 offset:64
    ds_read_b64_tr_b16 v[18:19], v52 offset:832
    ds_read_b64_tr_b16 v[20:21], v52 offset:96
    ds_read_b64_tr_b16 v[22:23], v52 offset:864
    ds_read_b64_tr_b16 v[24:25], v52 offset:128
    ds_read_b64_tr_b16 v[26:27], v52 offset:896
    ds_read_b64_tr_b16 v[28:29], v52 offset:160
    ds_read_b64_tr_b16 v[30:31], v52 offset:928
    s_mov_b32 s47, 0
    s_mov_b32 s44, 0
    s_mov_b32 s45, 0
    s_mov_b32 s84, 12320
    s_mov_b32 s85, 4294918016
    s_mov_b32 s82, 32768
    s_mov_b32 s83, 4294901760
    s_waitcnt lgkmcnt(0)
.p2align 6
gated_mix__mha_block__glu_gated_geglu__prompt_kernel_loop_f6:
    ds_read_b128 v[40:43], v49 offset:0
    ds_read_b128 v[44:47], v49 offset:4096
    s_waitcnt lgkmcnt(12)
    v_mfma_f32_32x32x16_bf16 v[64:79], v[8:11], v[32:35], v[64:79]
    v_mfma_f32_32x32x16_bf16 v[160:175], v[8:11], v[36:39], v[160:175]
    ds_read_b64_tr_b16 v[8:9], v52 offset:3072
    ds_read_b64_tr_b16 v[10:11], v52 offset:3840
    s_waitcnt lgkmcnt(12)
    v_mfma_f32_32x32x16_bf16 v[80:95], v[12:15], v[32:35], v[80:95]
    v_mfma_f32_32x32x16_bf16 v[176:191], v[12:15], v[36:39], v[176:191]
    ds_read_b64_tr_b16 v[12:13], v52 offset:3104
    ds_read_b64_tr_b16 v[14:15], v52 offset:3872
    s_waitcnt lgkmcnt(12)
    v_mfma_f32_32x32x16_bf16 v[96:111], v[16:19], v[32:35], v[96:111]
    v_mfma_f32_32x32x16_bf16 v[192:207], v[16:19], v[36:39], v[192:207]
    ds_read_b64_tr_b16 v[16:17], v52 offset:3136
    ds_read_b64_tr_b16 v[18:19], v52 offset:3904
    s_waitcnt lgkmcnt(12)
    v_mfma_f32_32x32x16_bf16 v[112:127], v[20:23], v[32:35], v[112:127]
    v_mfma_f32_32x32x16_bf16 v[208:223], v[20:23], v[36:39], v[208:223]
    ds_read_b64_tr_b16 v[20:21], v52 offset:3168
    ds_read_b64_tr_b16 v[22:23], v52 offset:3936
    s_waitcnt lgkmcnt(12)
    v_mfma_f32_32x32x16_bf16 v[128:143], v[24:27], v[32:35], v[128:143]
    v_mfma_f32_32x32x16_bf16 v[224:239], v[24:27], v[36:39], v[224:239]
    ds_read_b64_tr_b16 v[24:25], v52 offset:3200
    ds_read_b64_tr_b16 v[26:27], v52 offset:3968
    s_waitcnt lgkmcnt(12)
    v_mfma_f32_32x32x16_bf16 v[144:159], v[28:31], v[32:35], v[144:159]
    v_mfma_f32_32x32x16_bf16 v[240:255], v[28:31], v[36:39], v[240:255]
    ds_read_b64_tr_b16 v[28:29], v52 offset:3232
    ds_read_b64_tr_b16 v[30:31], v52 offset:4000
    s_waitcnt lgkmcnt(10)
    v_mfma_f32_32x32x16_bf16 v[64:79], v[8:11], v[40:43], v[64:79]
    v_mfma_f32_32x32x16_bf16 v[160:175], v[8:11], v[44:47], v[160:175]
    s_add_u32 s44, s44, 1
    s_cmp_eq_u32 s44, 5
    s_cselect_b32 s23, s85, s84
    s_cselect_b32 s44, 0, s44
    s_barrier
    v_add_u32 v52, s23, v52
    ds_read_b128 v[32:35], v50 offset:0
    ds_read_b128 v[36:39], v50 offset:4096
    ds_read_b64_tr_b16 v[8:9], v52 offset:0
    ds_read_b64_tr_b16 v[10:11], v52 offset:768
    s_waitcnt lgkmcnt(12)
    v_mfma_f32_32x32x16_bf16 v[80:95], v[12:15], v[40:43], v[80:95]
    v_mfma_f32_32x32x16_bf16 v[176:191], v[12:15], v[44:47], v[176:191]
    ds_read_b64_tr_b16 v[12:13], v52 offset:32
    ds_read_b64_tr_b16 v[14:15], v52 offset:800
    s_waitcnt lgkmcnt(12)
    v_mfma_f32_32x32x16_bf16 v[96:111], v[16:19], v[40:43], v[96:111]
    v_mfma_f32_32x32x16_bf16 v[192:207], v[16:19], v[44:47], v[192:207]
    ds_read_b64_tr_b16 v[16:17], v52 offset:64
    ds_read_b64_tr_b16 v[18:19], v52 offset:832
    s_waitcnt lgkmcnt(12)
    v_mfma_f32_32x32x16_bf16 v[112:127], v[20:23], v[40:43], v[112:127]
    v_mfma_f32_32x32x16_bf16 v[208:223], v[20:23], v[44:47], v[208:223]
    ds_read_b64_tr_b16 v[20:21], v52 offset:96
    ds_read_b64_tr_b16 v[22:23], v52 offset:864
    s_waitcnt lgkmcnt(12)
    v_mfma_f32_32x32x16_bf16 v[128:143], v[24:27], v[40:43], v[128:143]
    v_mfma_f32_32x32x16_bf16 v[224:239], v[24:27], v[44:47], v[224:239]
    ds_read_b64_tr_b16 v[24:25], v52 offset:128
    ds_read_b64_tr_b16 v[26:27], v52 offset:896
    s_waitcnt lgkmcnt(12)
    v_mfma_f32_32x32x16_bf16 v[144:159], v[28:31], v[40:43], v[144:159]
    v_mfma_f32_32x32x16_bf16 v[240:255], v[28:31], v[44:47], v[240:255]
    ds_read_b64_tr_b16 v[28:29], v52 offset:160
    ds_read_b64_tr_b16 v[30:31], v52 offset:928
    ds_read_b128 v[40:43], v51 offset:0
    ds_read_b128 v[44:47], v51 offset:4096
    s_waitcnt lgkmcnt(12)
    v_mfma_f32_32x32x16_bf16 v[64:79], v[8:11], v[32:35], v[64:79]
    v_mfma_f32_32x32x16_bf16 v[160:175], v[8:11], v[36:39], v[160:175]
    ds_read_b64_tr_b16 v[8:9], v52 offset:3072
    ds_read_b64_tr_b16 v[10:11], v52 offset:3840
    s_waitcnt lgkmcnt(12)
    v_mfma_f32_32x32x16_bf16 v[80:95], v[12:15], v[32:35], v[80:95]
    v_mfma_f32_32x32x16_bf16 v[176:191], v[12:15], v[36:39], v[176:191]
    ds_read_b64_tr_b16 v[12:13], v52 offset:3104
    ds_read_b64_tr_b16 v[14:15], v52 offset:3872
    s_waitcnt lgkmcnt(12)
    v_mfma_f32_32x32x16_bf16 v[96:111], v[16:19], v[32:35], v[96:111]
    v_mfma_f32_32x32x16_bf16 v[192:207], v[16:19], v[36:39], v[192:207]
    ds_read_b64_tr_b16 v[16:17], v52 offset:3136
    ds_read_b64_tr_b16 v[18:19], v52 offset:3904
    s_waitcnt lgkmcnt(12)
    v_mfma_f32_32x32x16_bf16 v[112:127], v[20:23], v[32:35], v[112:127]
    v_mfma_f32_32x32x16_bf16 v[208:223], v[20:23], v[36:39], v[208:223]
    ds_read_b64_tr_b16 v[20:21], v52 offset:3168
    ds_read_b64_tr_b16 v[22:23], v52 offset:3936
    s_waitcnt lgkmcnt(12)
    v_mfma_f32_32x32x16_bf16 v[128:143], v[24:27], v[32:35], v[128:143]
    v_mfma_f32_32x32x16_bf16 v[224:239], v[24:27], v[36:39], v[224:239]
    ds_read_b64_tr_b16 v[24:25], v52 offset:3200
    ds_read_b64_tr_b16 v[26:27], v52 offset:3968
    s_waitcnt lgkmcnt(12)
    v_mfma_f32_32x32x16_bf16 v[144:159], v[28:31], v[32:35], v[144:159]
    v_mfma_f32_32x32x16_bf16 v[240:255], v[28:31], v[36:39], v[240:255]
    ds_read_b64_tr_b16 v[28:29], v52 offset:3232
    ds_read_b64_tr_b16 v[30:31], v52 offset:4000
    s_waitcnt lgkmcnt(10)
    v_mfma_f32_32x32x16_bf16 v[64:79], v[8:11], v[40:43], v[64:79]
    v_mfma_f32_32x32x16_bf16 v[160:175], v[8:11], v[44:47], v[160:175]
    s_add_u32 s44, s44, 1
    s_cmp_eq_u32 s44, 5
    s_cselect_b32 s23, s85, s84
    s_cselect_b32 s44, 0, s44
    s_add_u32 s45, s45, 1
    s_cmp_eq_u32 s45, 3
    s_cselect_b32 s24, s83, s82
    s_cselect_b32 s45, 0, s45
    s_cmp_eq_u32 s47, 0
    s_cbranch_scc0 gated_mix__mha_block__glu_gated_geglu__prompt_kernel_nw_f6
    s_waitcnt vmcnt(0)
gated_mix__mha_block__glu_gated_geglu__prompt_kernel_nw_f6:
    s_barrier
    v_add_u32 v52, s23, v52
    v_add_u32 v48, s24, v48
    v_add_u32 v49, s24, v49
    v_add_u32 v50, s24, v50
    v_add_u32 v51, s24, v51
    ds_read_b128 v[32:35], v48 offset:0
    ds_read_b128 v[36:39], v48 offset:4096
    ds_read_b64_tr_b16 v[8:9], v52 offset:0
    ds_read_b64_tr_b16 v[10:11], v52 offset:768
    s_waitcnt lgkmcnt(12)
    v_mfma_f32_32x32x16_bf16 v[80:95], v[12:15], v[40:43], v[80:95]
    v_mfma_f32_32x32x16_bf16 v[176:191], v[12:15], v[44:47], v[176:191]
    ds_read_b64_tr_b16 v[12:13], v52 offset:32
    ds_read_b64_tr_b16 v[14:15], v52 offset:800
    s_waitcnt lgkmcnt(12)
    v_mfma_f32_32x32x16_bf16 v[96:111], v[16:19], v[40:43], v[96:111]
    v_mfma_f32_32x32x16_bf16 v[192:207], v[16:19], v[44:47], v[192:207]
    ds_read_b64_tr_b16 v[16:17], v52 offset:64
    ds_read_b64_tr_b16 v[18:19], v52 offset:832
    s_waitcnt lgkmcnt(12)
    v_mfma_f32_32x32x16_bf16 v[112:127], v[20:23], v[40:43], v[112:127]
    v_mfma_f32_32x32x16_bf16 v[208:223], v[20:23], v[44:47], v[208:223]
    ds_read_b64_tr_b16 v[20:21], v52 offset:96
    ds_read_b64_tr_b16 v[22:23], v52 offset:864
    s_waitcnt lgkmcnt(12)
    v_mfma_f32_32x32x16_bf16 v[128:143], v[24:27], v[40:43], v[128:143]
    v_mfma_f32_32x32x16_bf16 v[224:239], v[24:27], v[44:47], v[224:239]
    ds_read_b64_tr_b16 v[24:25], v52 offset:128
    ds_read_b64_tr_b16 v[26:27], v52 offset:896
    s_waitcnt lgkmcnt(12)
    v_mfma_f32_32x32x16_bf16 v[144:159], v[28:31], v[40:43], v[144:159]
    v_mfma_f32_32x32x16_bf16 v[240:255], v[28:31], v[44:47], v[240:255]
    ds_read_b64_tr_b16 v[28:29], v52 offset:160
    ds_read_b64_tr_b16 v[30:31], v52 offset:928
    s_add_u32 s47, s47, 1
    s_cmp_lt_u32 s47, 10
    s_cbranch_scc1 gated_mix__mha_block__glu_gated_geglu__prompt_kernel_loop_f6
    s_waitcnt lgkmcnt(0)
    s_barrier
    s_nop 15
    v_mov_b32 v8, 0xc0135761
    v_mov_b32 v10, 0xbdd2d3e8
    v_mov_b32 v12, 1.0
    v_mov_b32 v9, 0xc0135761
    v_mov_b32 v11, 0xbdd2d3e8
    v_mov_b32 v13, 1.0
    v_lshlrev_b32 v3, 4, v2
    v_add_u32 v4, 4096, v3
    s_lshl_b32 s24, s20, 3
    s_lshl_b32 s25, s22, 1
    s_add_u32 s24, s24, s25
    s_mul_i32 s24, s24, 98304
    s_mul_i32 s25, s21, 6144
    s_add_u32 s24, s24, s25
    s_add_u32 s24, s24, 9437184
    s_add_u32 s25, s24, 98304
    v_pk_mul_f32 v[14:15], v[64:65], v[64:65]
    v_pk_mul_f32 v[20:21], v[64:65], v[72:73]
    v_pk_fma_f32 v[16:17], v[14:15], v[10:11], v[8:9]
    v_pk_mul_f32 v[16:17], v[16:17], v[64:65]
    v_exp_f32 v18, v16
    v_exp_f32 v19, v17
    s_nop 0
    v_pk_add_f32 v[18:19], v[18:19], v[12:13]
    v_rcp_f32 v18, v18
    v_rcp_f32 v19, v19
    s_nop 0
    v_pk_mul_f32 v[20:21], v[20:21], v[18:19]
    v_cvt_pk_bf16_f32 v24, v20, v21
    v_pk_mul_f32 v[14:15], v[66:67], v[66:67]
    v_pk_mul_f32 v[20:21], v[66:67], v[74:75]
    v_pk_fma_f32 v[16:17], v[14:15], v[10:11], v[8:9]
    v_pk_mul_f32 v[16:17], v[16:17], v[66:67]
    v_exp_f32 v18, v16
    v_exp_f32 v19, v17
    s_nop 0
    v_pk_add_f32 v[18:19], v[18:19], v[12:13]
    v_rcp_f32 v18, v18
    v_rcp_f32 v19, v19
    s_nop 0
    v_pk_mul_f32 v[20:21], v[20:21], v[18:19]
    v_cvt_pk_bf16_f32 v25, v20, v21
    v_pk_mul_f32 v[14:15], v[68:69], v[68:69]
    v_pk_mul_f32 v[20:21], v[68:69], v[76:77]
    v_pk_fma_f32 v[16:17], v[14:15], v[10:11], v[8:9]
    v_pk_mul_f32 v[16:17], v[16:17], v[68:69]
    v_exp_f32 v18, v16
    v_exp_f32 v19, v17
    s_nop 0
    v_pk_add_f32 v[18:19], v[18:19], v[12:13]
    v_rcp_f32 v18, v18
    v_rcp_f32 v19, v19
    s_nop 0
    v_pk_mul_f32 v[20:21], v[20:21], v[18:19]
    v_cvt_pk_bf16_f32 v26, v20, v21
    v_pk_mul_f32 v[14:15], v[70:71], v[70:71]
    v_pk_mul_f32 v[20:21], v[70:71], v[78:79]
    v_pk_fma_f32 v[16:17], v[14:15], v[10:11], v[8:9]
    v_pk_mul_f32 v[16:17], v[16:17], v[70:71]
    v_exp_f32 v18, v16
    v_exp_f32 v19, v17
    s_nop 0
    v_pk_add_f32 v[18:19], v[18:19], v[12:13]
    v_rcp_f32 v18, v18
    v_rcp_f32 v19, v19
    s_nop 0
    v_pk_mul_f32 v[20:21], v[20:21], v[18:19]
    v_cvt_pk_bf16_f32 v27, v20, v21
    buffer_store_dwordx4 v[24:27], v3, s[40:43], s24 offen offset:0 sc1
    v_pk_mul_f32 v[14:15], v[160:161], v[160:161]
    v_pk_mul_f32 v[20:21], v[160:161], v[168:169]
    v_pk_fma_f32 v[16:17], v[14:15], v[10:11], v[8:9]
    v_pk_mul_f32 v[16:17], v[16:17], v[160:161]
    v_exp_f32 v18, v16
    v_exp_f32 v19, v17
    s_nop 0
    v_pk_add_f32 v[18:19], v[18:19], v[12:13]
    v_rcp_f32 v18, v18
    v_rcp_f32 v19, v19
    s_nop 0
    v_pk_mul_f32 v[20:21], v[20:21], v[18:19]
    v_cvt_pk_bf16_f32 v28, v20, v21
    v_pk_mul_f32 v[14:15], v[162:163], v[162:163]
    v_pk_mul_f32 v[20:21], v[162:163], v[170:171]
    v_pk_fma_f32 v[16:17], v[14:15], v[10:11], v[8:9]
    v_pk_mul_f32 v[16:17], v[16:17], v[162:163]
    v_exp_f32 v18, v16
    v_exp_f32 v19, v17
    s_nop 0
    v_pk_add_f32 v[18:19], v[18:19], v[12:13]
    v_rcp_f32 v18, v18
    v_rcp_f32 v19, v19
    s_nop 0
    v_pk_mul_f32 v[20:21], v[20:21], v[18:19]
    v_cvt_pk_bf16_f32 v29, v20, v21
    v_pk_mul_f32 v[14:15], v[164:165], v[164:165]
    v_pk_mul_f32 v[20:21], v[164:165], v[172:173]
    v_pk_fma_f32 v[16:17], v[14:15], v[10:11], v[8:9]
    v_pk_mul_f32 v[16:17], v[16:17], v[164:165]
    v_exp_f32 v18, v16
    v_exp_f32 v19, v17
    s_nop 0
    v_pk_add_f32 v[18:19], v[18:19], v[12:13]
    v_rcp_f32 v18, v18
    v_rcp_f32 v19, v19
    s_nop 0
    v_pk_mul_f32 v[20:21], v[20:21], v[18:19]
    v_cvt_pk_bf16_f32 v30, v20, v21
    v_pk_mul_f32 v[14:15], v[166:167], v[166:167]
    v_pk_mul_f32 v[20:21], v[166:167], v[174:175]
    v_pk_fma_f32 v[16:17], v[14:15], v[10:11], v[8:9]
    v_pk_mul_f32 v[16:17], v[16:17], v[166:167]
    v_exp_f32 v18, v16
    v_exp_f32 v19, v17
    s_nop 0
    v_pk_add_f32 v[18:19], v[18:19], v[12:13]
    v_rcp_f32 v18, v18
    v_rcp_f32 v19, v19
    s_nop 0
    v_pk_mul_f32 v[20:21], v[20:21], v[18:19]
    v_cvt_pk_bf16_f32 v31, v20, v21
    buffer_store_dwordx4 v[28:31], v3, s[40:43], s25 offen offset:0 sc1
    v_pk_mul_f32 v[14:15], v[80:81], v[80:81]
    v_pk_mul_f32 v[20:21], v[80:81], v[88:89]
    v_pk_fma_f32 v[16:17], v[14:15], v[10:11], v[8:9]
    v_pk_mul_f32 v[16:17], v[16:17], v[80:81]
    v_exp_f32 v18, v16
    v_exp_f32 v19, v17
    s_nop 0
    v_pk_add_f32 v[18:19], v[18:19], v[12:13]
    v_rcp_f32 v18, v18
    v_rcp_f32 v19, v19
    s_nop 0
    v_pk_mul_f32 v[20:21], v[20:21], v[18:19]
    v_cvt_pk_bf16_f32 v24, v20, v21
    v_pk_mul_f32 v[14:15], v[82:83], v[82:83]
    v_pk_mul_f32 v[20:21], v[82:83], v[90:91]
    v_pk_fma_f32 v[16:17], v[14:15], v[10:11], v[8:9]
    v_pk_mul_f32 v[16:17], v[16:17], v[82:83]
    v_exp_f32 v18, v16
    v_exp_f32 v19, v17
    s_nop 0
    v_pk_add_f32 v[18:19], v[18:19], v[12:13]
    v_rcp_f32 v18, v18
    v_rcp_f32 v19, v19
    s_nop 0
    v_pk_mul_f32 v[20:21], v[20:21], v[18:19]
    v_cvt_pk_bf16_f32 v25, v20, v21
    v_pk_mul_f32 v[14:15], v[84:85], v[84:85]
    v_pk_mul_f32 v[20:21], v[84:85], v[92:93]
    v_pk_fma_f32 v[16:17], v[14:15], v[10:11], v[8:9]
    v_pk_mul_f32 v[16:17], v[16:17], v[84:85]
    v_exp_f32 v18, v16
    v_exp_f32 v19, v17
    s_nop 0
    v_pk_add_f32 v[18:19], v[18:19], v[12:13]
    v_rcp_f32 v18, v18
    v_rcp_f32 v19, v19
    s_nop 0
    v_pk_mul_f32 v[20:21], v[20:21], v[18:19]
    v_cvt_pk_bf16_f32 v26, v20, v21
    v_pk_mul_f32 v[14:15], v[86:87], v[86:87]
    v_pk_mul_f32 v[20:21], v[86:87], v[94:95]
    v_pk_fma_f32 v[16:17], v[14:15], v[10:11], v[8:9]
    v_pk_mul_f32 v[16:17], v[16:17], v[86:87]
    v_exp_f32 v18, v16
    v_exp_f32 v19, v17
    s_nop 0
    v_pk_add_f32 v[18:19], v[18:19], v[12:13]
    v_rcp_f32 v18, v18
    v_rcp_f32 v19, v19
    s_nop 0
    v_pk_mul_f32 v[20:21], v[20:21], v[18:19]
    v_cvt_pk_bf16_f32 v27, v20, v21
    buffer_store_dwordx4 v[24:27], v3, s[40:43], s24 offen offset:1024 sc1
    v_pk_mul_f32 v[14:15], v[176:177], v[176:177]
    v_pk_mul_f32 v[20:21], v[176:177], v[184:185]
    v_pk_fma_f32 v[16:17], v[14:15], v[10:11], v[8:9]
    v_pk_mul_f32 v[16:17], v[16:17], v[176:177]
    v_exp_f32 v18, v16
    v_exp_f32 v19, v17
    s_nop 0
    v_pk_add_f32 v[18:19], v[18:19], v[12:13]
    v_rcp_f32 v18, v18
    v_rcp_f32 v19, v19
    s_nop 0
    v_pk_mul_f32 v[20:21], v[20:21], v[18:19]
    v_cvt_pk_bf16_f32 v28, v20, v21
    v_pk_mul_f32 v[14:15], v[178:179], v[178:179]
    v_pk_mul_f32 v[20:21], v[178:179], v[186:187]
    v_pk_fma_f32 v[16:17], v[14:15], v[10:11], v[8:9]
    v_pk_mul_f32 v[16:17], v[16:17], v[178:179]
    v_exp_f32 v18, v16
    v_exp_f32 v19, v17
    s_nop 0
    v_pk_add_f32 v[18:19], v[18:19], v[12:13]
    v_rcp_f32 v18, v18
    v_rcp_f32 v19, v19
    s_nop 0
    v_pk_mul_f32 v[20:21], v[20:21], v[18:19]
    v_cvt_pk_bf16_f32 v29, v20, v21
    v_pk_mul_f32 v[14:15], v[180:181], v[180:181]
    v_pk_mul_f32 v[20:21], v[180:181], v[188:189]
    v_pk_fma_f32 v[16:17], v[14:15], v[10:11], v[8:9]
    v_pk_mul_f32 v[16:17], v[16:17], v[180:181]
    v_exp_f32 v18, v16
    v_exp_f32 v19, v17
    s_nop 0
    v_pk_add_f32 v[18:19], v[18:19], v[12:13]
    v_rcp_f32 v18, v18
    v_rcp_f32 v19, v19
    s_nop 0
    v_pk_mul_f32 v[20:21], v[20:21], v[18:19]
    v_cvt_pk_bf16_f32 v30, v20, v21
    v_pk_mul_f32 v[14:15], v[182:183], v[182:183]
    v_pk_mul_f32 v[20:21], v[182:183], v[190:191]
    v_pk_fma_f32 v[16:17], v[14:15], v[10:11], v[8:9]
    v_pk_mul_f32 v[16:17], v[16:17], v[182:183]
    v_exp_f32 v18, v16
    v_exp_f32 v19, v17
    s_nop 0
    v_pk_add_f32 v[18:19], v[18:19], v[12:13]
    v_rcp_f32 v18, v18
    v_rcp_f32 v19, v19
    s_nop 0
    v_pk_mul_f32 v[20:21], v[20:21], v[18:19]
    v_cvt_pk_bf16_f32 v31, v20, v21
    buffer_store_dwordx4 v[28:31], v3, s[40:43], s25 offen offset:1024 sc1
    v_pk_mul_f32 v[14:15], v[96:97], v[96:97]
    v_pk_mul_f32 v[20:21], v[96:97], v[104:105]
    v_pk_fma_f32 v[16:17], v[14:15], v[10:11], v[8:9]
    v_pk_mul_f32 v[16:17], v[16:17], v[96:97]
    v_exp_f32 v18, v16
    v_exp_f32 v19, v17
    s_nop 0
    v_pk_add_f32 v[18:19], v[18:19], v[12:13]
    v_rcp_f32 v18, v18
    v_rcp_f32 v19, v19
    s_nop 0
    v_pk_mul_f32 v[20:21], v[20:21], v[18:19]
    v_cvt_pk_bf16_f32 v24, v20, v21
    v_pk_mul_f32 v[14:15], v[98:99], v[98:99]
    v_pk_mul_f32 v[20:21], v[98:99], v[106:107]
    v_pk_fma_f32 v[16:17], v[14:15], v[10:11], v[8:9]
    v_pk_mul_f32 v[16:17], v[16:17], v[98:99]
    v_exp_f32 v18, v16
    v_exp_f32 v19, v17
    s_nop 0
    v_pk_add_f32 v[18:19], v[18:19], v[12:13]
    v_rcp_f32 v18, v18
    v_rcp_f32 v19, v19
    s_nop 0
    v_pk_mul_f32 v[20:21], v[20:21], v[18:19]
    v_cvt_pk_bf16_f32 v25, v20, v21
    v_pk_mul_f32 v[14:15], v[100:101], v[100:101]
    v_pk_mul_f32 v[20:21], v[100:101], v[108:109]
    v_pk_fma_f32 v[16:17], v[14:15], v[10:11], v[8:9]
    v_pk_mul_f32 v[16:17], v[16:17], v[100:101]
    v_exp_f32 v18, v16
    v_exp_f32 v19, v17
    s_nop 0
    v_pk_add_f32 v[18:19], v[18:19], v[12:13]
    v_rcp_f32 v18, v18
    v_rcp_f32 v19, v19
    s_nop 0
    v_pk_mul_f32 v[20:21], v[20:21], v[18:19]
    v_cvt_pk_bf16_f32 v26, v20, v21
    v_pk_mul_f32 v[14:15], v[102:103], v[102:103]
    v_pk_mul_f32 v[20:21], v[102:103], v[110:111]
    v_pk_fma_f32 v[16:17], v[14:15], v[10:11], v[8:9]
    v_pk_mul_f32 v[16:17], v[16:17], v[102:103]
    v_exp_f32 v18, v16
    v_exp_f32 v19, v17
    s_nop 0
    v_pk_add_f32 v[18:19], v[18:19], v[12:13]
    v_rcp_f32 v18, v18
    v_rcp_f32 v19, v19
    s_nop 0
    v_pk_mul_f32 v[20:21], v[20:21], v[18:19]
    v_cvt_pk_bf16_f32 v27, v20, v21
    buffer_store_dwordx4 v[24:27], v3, s[40:43], s24 offen offset:2048 sc1
    v_pk_mul_f32 v[14:15], v[192:193], v[192:193]
    v_pk_mul_f32 v[20:21], v[192:193], v[200:201]
    v_pk_fma_f32 v[16:17], v[14:15], v[10:11], v[8:9]
    v_pk_mul_f32 v[16:17], v[16:17], v[192:193]
    v_exp_f32 v18, v16
    v_exp_f32 v19, v17
    s_nop 0
    v_pk_add_f32 v[18:19], v[18:19], v[12:13]
    v_rcp_f32 v18, v18
    v_rcp_f32 v19, v19
    s_nop 0
    v_pk_mul_f32 v[20:21], v[20:21], v[18:19]
    v_cvt_pk_bf16_f32 v28, v20, v21
    v_pk_mul_f32 v[14:15], v[194:195], v[194:195]
    v_pk_mul_f32 v[20:21], v[194:195], v[202:203]
    v_pk_fma_f32 v[16:17], v[14:15], v[10:11], v[8:9]
    v_pk_mul_f32 v[16:17], v[16:17], v[194:195]
    v_exp_f32 v18, v16
    v_exp_f32 v19, v17
    s_nop 0
    v_pk_add_f32 v[18:19], v[18:19], v[12:13]
    v_rcp_f32 v18, v18
    v_rcp_f32 v19, v19
    s_nop 0
    v_pk_mul_f32 v[20:21], v[20:21], v[18:19]
    v_cvt_pk_bf16_f32 v29, v20, v21
    v_pk_mul_f32 v[14:15], v[196:197], v[196:197]
    v_pk_mul_f32 v[20:21], v[196:197], v[204:205]
    v_pk_fma_f32 v[16:17], v[14:15], v[10:11], v[8:9]
    v_pk_mul_f32 v[16:17], v[16:17], v[196:197]
    v_exp_f32 v18, v16
    v_exp_f32 v19, v17
    s_nop 0
    v_pk_add_f32 v[18:19], v[18:19], v[12:13]
    v_rcp_f32 v18, v18
    v_rcp_f32 v19, v19
    s_nop 0
    v_pk_mul_f32 v[20:21], v[20:21], v[18:19]
    v_cvt_pk_bf16_f32 v30, v20, v21
    v_pk_mul_f32 v[14:15], v[198:199], v[198:199]
    v_pk_mul_f32 v[20:21], v[198:199], v[206:207]
    v_pk_fma_f32 v[16:17], v[14:15], v[10:11], v[8:9]
    v_pk_mul_f32 v[16:17], v[16:17], v[198:199]
    v_exp_f32 v18, v16
    v_exp_f32 v19, v17
    s_nop 0
    v_pk_add_f32 v[18:19], v[18:19], v[12:13]
    v_rcp_f32 v18, v18
    v_rcp_f32 v19, v19
    s_nop 0
    v_pk_mul_f32 v[20:21], v[20:21], v[18:19]
    v_cvt_pk_bf16_f32 v31, v20, v21
    buffer_store_dwordx4 v[28:31], v3, s[40:43], s25 offen offset:2048 sc1
    v_pk_mul_f32 v[14:15], v[112:113], v[112:113]
    v_pk_mul_f32 v[20:21], v[112:113], v[120:121]
    v_pk_fma_f32 v[16:17], v[14:15], v[10:11], v[8:9]
    v_pk_mul_f32 v[16:17], v[16:17], v[112:113]
    v_exp_f32 v18, v16
    v_exp_f32 v19, v17
    s_nop 0
    v_pk_add_f32 v[18:19], v[18:19], v[12:13]
    v_rcp_f32 v18, v18
    v_rcp_f32 v19, v19
    s_nop 0
    v_pk_mul_f32 v[20:21], v[20:21], v[18:19]
    v_cvt_pk_bf16_f32 v24, v20, v21
    v_pk_mul_f32 v[14:15], v[114:115], v[114:115]
    v_pk_mul_f32 v[20:21], v[114:115], v[122:123]
    v_pk_fma_f32 v[16:17], v[14:15], v[10:11], v[8:9]
    v_pk_mul_f32 v[16:17], v[16:17], v[114:115]
    v_exp_f32 v18, v16
    v_exp_f32 v19, v17
    s_nop 0
    v_pk_add_f32 v[18:19], v[18:19], v[12:13]
    v_rcp_f32 v18, v18
    v_rcp_f32 v19, v19
    s_nop 0
    v_pk_mul_f32 v[20:21], v[20:21], v[18:19]
    v_cvt_pk_bf16_f32 v25, v20, v21
    v_pk_mul_f32 v[14:15], v[116:117], v[116:117]
    v_pk_mul_f32 v[20:21], v[116:117], v[124:125]
    v_pk_fma_f32 v[16:17], v[14:15], v[10:11], v[8:9]
    v_pk_mul_f32 v[16:17], v[16:17], v[116:117]
    v_exp_f32 v18, v16
    v_exp_f32 v19, v17
    s_nop 0
    v_pk_add_f32 v[18:19], v[18:19], v[12:13]
    v_rcp_f32 v18, v18
    v_rcp_f32 v19, v19
    s_nop 0
    v_pk_mul_f32 v[20:21], v[20:21], v[18:19]
    v_cvt_pk_bf16_f32 v26, v20, v21
    v_pk_mul_f32 v[14:15], v[118:119], v[118:119]
    v_pk_mul_f32 v[20:21], v[118:119], v[126:127]
    v_pk_fma_f32 v[16:17], v[14:15], v[10:11], v[8:9]
    v_pk_mul_f32 v[16:17], v[16:17], v[118:119]
    v_exp_f32 v18, v16
    v_exp_f32 v19, v17
    s_nop 0
    v_pk_add_f32 v[18:19], v[18:19], v[12:13]
    v_rcp_f32 v18, v18
    v_rcp_f32 v19, v19
    s_nop 0
    v_pk_mul_f32 v[20:21], v[20:21], v[18:19]
    v_cvt_pk_bf16_f32 v27, v20, v21
    buffer_store_dwordx4 v[24:27], v3, s[40:43], s24 offen offset:3072 sc1
    v_pk_mul_f32 v[14:15], v[208:209], v[208:209]
    v_pk_mul_f32 v[20:21], v[208:209], v[216:217]
    v_pk_fma_f32 v[16:17], v[14:15], v[10:11], v[8:9]
    v_pk_mul_f32 v[16:17], v[16:17], v[208:209]
    v_exp_f32 v18, v16
    v_exp_f32 v19, v17
    s_nop 0
    v_pk_add_f32 v[18:19], v[18:19], v[12:13]
    v_rcp_f32 v18, v18
    v_rcp_f32 v19, v19
    s_nop 0
    v_pk_mul_f32 v[20:21], v[20:21], v[18:19]
    v_cvt_pk_bf16_f32 v28, v20, v21
    v_pk_mul_f32 v[14:15], v[210:211], v[210:211]
    v_pk_mul_f32 v[20:21], v[210:211], v[218:219]
    v_pk_fma_f32 v[16:17], v[14:15], v[10:11], v[8:9]
    v_pk_mul_f32 v[16:17], v[16:17], v[210:211]
    v_exp_f32 v18, v16
    v_exp_f32 v19, v17
    s_nop 0
    v_pk_add_f32 v[18:19], v[18:19], v[12:13]
    v_rcp_f32 v18, v18
    v_rcp_f32 v19, v19
    s_nop 0
    v_pk_mul_f32 v[20:21], v[20:21], v[18:19]
    v_cvt_pk_bf16_f32 v29, v20, v21
    v_pk_mul_f32 v[14:15], v[212:213], v[212:213]
    v_pk_mul_f32 v[20:21], v[212:213], v[220:221]
    v_pk_fma_f32 v[16:17], v[14:15], v[10:11], v[8:9]
    v_pk_mul_f32 v[16:17], v[16:17], v[212:213]
    v_exp_f32 v18, v16
    v_exp_f32 v19, v17
    s_nop 0
    v_pk_add_f32 v[18:19], v[18:19], v[12:13]
    v_rcp_f32 v18, v18
    v_rcp_f32 v19, v19
    s_nop 0
    v_pk_mul_f32 v[20:21], v[20:21], v[18:19]
    v_cvt_pk_bf16_f32 v30, v20, v21
    v_pk_mul_f32 v[14:15], v[214:215], v[214:215]
    v_pk_mul_f32 v[20:21], v[214:215], v[222:223]
    v_pk_fma_f32 v[16:17], v[14:15], v[10:11], v[8:9]
    v_pk_mul_f32 v[16:17], v[16:17], v[214:215]
    v_exp_f32 v18, v16
    v_exp_f32 v19, v17
    s_nop 0
    v_pk_add_f32 v[18:19], v[18:19], v[12:13]
    v_rcp_f32 v18, v18
    v_rcp_f32 v19, v19
    s_nop 0
    v_pk_mul_f32 v[20:21], v[20:21], v[18:19]
    v_cvt_pk_bf16_f32 v31, v20, v21
    buffer_store_dwordx4 v[28:31], v3, s[40:43], s25 offen offset:3072 sc1
    v_pk_mul_f32 v[14:15], v[128:129], v[128:129]
    v_pk_mul_f32 v[20:21], v[128:129], v[136:137]
    v_pk_fma_f32 v[16:17], v[14:15], v[10:11], v[8:9]
    v_pk_mul_f32 v[16:17], v[16:17], v[128:129]
    v_exp_f32 v18, v16
    v_exp_f32 v19, v17
    s_nop 0
    v_pk_add_f32 v[18:19], v[18:19], v[12:13]
    v_rcp_f32 v18, v18
    v_rcp_f32 v19, v19
    s_nop 0
    v_pk_mul_f32 v[20:21], v[20:21], v[18:19]
    v_cvt_pk_bf16_f32 v24, v20, v21
    v_pk_mul_f32 v[14:15], v[130:131], v[130:131]
    v_pk_mul_f32 v[20:21], v[130:131], v[138:139]
    v_pk_fma_f32 v[16:17], v[14:15], v[10:11], v[8:9]
    v_pk_mul_f32 v[16:17], v[16:17], v[130:131]
    v_exp_f32 v18, v16
    v_exp_f32 v19, v17
    s_nop 0
    v_pk_add_f32 v[18:19], v[18:19], v[12:13]
    v_rcp_f32 v18, v18
    v_rcp_f32 v19, v19
    s_nop 0
    v_pk_mul_f32 v[20:21], v[20:21], v[18:19]
    v_cvt_pk_bf16_f32 v25, v20, v21
    v_pk_mul_f32 v[14:15], v[132:133], v[132:133]
    v_pk_mul_f32 v[20:21], v[132:133], v[140:141]
    v_pk_fma_f32 v[16:17], v[14:15], v[10:11], v[8:9]
    v_pk_mul_f32 v[16:17], v[16:17], v[132:133]
    v_exp_f32 v18, v16
    v_exp_f32 v19, v17
    s_nop 0
    v_pk_add_f32 v[18:19], v[18:19], v[12:13]
    v_rcp_f32 v18, v18
    v_rcp_f32 v19, v19
    s_nop 0
    v_pk_mul_f32 v[20:21], v[20:21], v[18:19]
    v_cvt_pk_bf16_f32 v26, v20, v21
    v_pk_mul_f32 v[14:15], v[134:135], v[134:135]
    v_pk_mul_f32 v[20:21], v[134:135], v[142:143]
    v_pk_fma_f32 v[16:17], v[14:15], v[10:11], v[8:9]
    v_pk_mul_f32 v[16:17], v[16:17], v[134:135]
    v_exp_f32 v18, v16
    v_exp_f32 v19, v17
    s_nop 0
    v_pk_add_f32 v[18:19], v[18:19], v[12:13]
    v_rcp_f32 v18, v18
    v_rcp_f32 v19, v19
    s_nop 0
    v_pk_mul_f32 v[20:21], v[20:21], v[18:19]
    v_cvt_pk_bf16_f32 v27, v20, v21
    buffer_store_dwordx4 v[24:27], v4, s[40:43], s24 offen offset:0 sc1
    v_pk_mul_f32 v[14:15], v[224:225], v[224:225]
    v_pk_mul_f32 v[20:21], v[224:225], v[232:233]
    v_pk_fma_f32 v[16:17], v[14:15], v[10:11], v[8:9]
    v_pk_mul_f32 v[16:17], v[16:17], v[224:225]
    v_exp_f32 v18, v16
    v_exp_f32 v19, v17
    s_nop 0
    v_pk_add_f32 v[18:19], v[18:19], v[12:13]
    v_rcp_f32 v18, v18
    v_rcp_f32 v19, v19
    s_nop 0
    v_pk_mul_f32 v[20:21], v[20:21], v[18:19]
    v_cvt_pk_bf16_f32 v28, v20, v21
    v_pk_mul_f32 v[14:15], v[226:227], v[226:227]
    v_pk_mul_f32 v[20:21], v[226:227], v[234:235]
    v_pk_fma_f32 v[16:17], v[14:15], v[10:11], v[8:9]
    v_pk_mul_f32 v[16:17], v[16:17], v[226:227]
    v_exp_f32 v18, v16
    v_exp_f32 v19, v17
    s_nop 0
    v_pk_add_f32 v[18:19], v[18:19], v[12:13]
    v_rcp_f32 v18, v18
    v_rcp_f32 v19, v19
    s_nop 0
    v_pk_mul_f32 v[20:21], v[20:21], v[18:19]
    v_cvt_pk_bf16_f32 v29, v20, v21
    v_pk_mul_f32 v[14:15], v[228:229], v[228:229]
    v_pk_mul_f32 v[20:21], v[228:229], v[236:237]
    v_pk_fma_f32 v[16:17], v[14:15], v[10:11], v[8:9]
    v_pk_mul_f32 v[16:17], v[16:17], v[228:229]
    v_exp_f32 v18, v16
    v_exp_f32 v19, v17
    s_nop 0
    v_pk_add_f32 v[18:19], v[18:19], v[12:13]
    v_rcp_f32 v18, v18
    v_rcp_f32 v19, v19
    s_nop 0
    v_pk_mul_f32 v[20:21], v[20:21], v[18:19]
    v_cvt_pk_bf16_f32 v30, v20, v21
    v_pk_mul_f32 v[14:15], v[230:231], v[230:231]
    v_pk_mul_f32 v[20:21], v[230:231], v[238:239]
    v_pk_fma_f32 v[16:17], v[14:15], v[10:11], v[8:9]
    v_pk_mul_f32 v[16:17], v[16:17], v[230:231]
    v_exp_f32 v18, v16
    v_exp_f32 v19, v17
    s_nop 0
    v_pk_add_f32 v[18:19], v[18:19], v[12:13]
    v_rcp_f32 v18, v18
    v_rcp_f32 v19, v19
    s_nop 0
    v_pk_mul_f32 v[20:21], v[20:21], v[18:19]
    v_cvt_pk_bf16_f32 v31, v20, v21
    buffer_store_dwordx4 v[28:31], v4, s[40:43], s25 offen offset:0 sc1
    v_pk_mul_f32 v[14:15], v[144:145], v[144:145]
    v_pk_mul_f32 v[20:21], v[144:145], v[152:153]
    v_pk_fma_f32 v[16:17], v[14:15], v[10:11], v[8:9]
    v_pk_mul_f32 v[16:17], v[16:17], v[144:145]
    v_exp_f32 v18, v16
    v_exp_f32 v19, v17
    s_nop 0
    v_pk_add_f32 v[18:19], v[18:19], v[12:13]
    v_rcp_f32 v18, v18
    v_rcp_f32 v19, v19
    s_nop 0
    v_pk_mul_f32 v[20:21], v[20:21], v[18:19]
    v_cvt_pk_bf16_f32 v24, v20, v21
    v_pk_mul_f32 v[14:15], v[146:147], v[146:147]
    v_pk_mul_f32 v[20:21], v[146:147], v[154:155]
    v_pk_fma_f32 v[16:17], v[14:15], v[10:11], v[8:9]
    v_pk_mul_f32 v[16:17], v[16:17], v[146:147]
    v_exp_f32 v18, v16
    v_exp_f32 v19, v17
    s_nop 0
    v_pk_add_f32 v[18:19], v[18:19], v[12:13]
    v_rcp_f32 v18, v18
    v_rcp_f32 v19, v19
    s_nop 0
    v_pk_mul_f32 v[20:21], v[20:21], v[18:19]
    v_cvt_pk_bf16_f32 v25, v20, v21
    v_pk_mul_f32 v[14:15], v[148:149], v[148:149]
    v_pk_mul_f32 v[20:21], v[148:149], v[156:157]
    v_pk_fma_f32 v[16:17], v[14:15], v[10:11], v[8:9]
    v_pk_mul_f32 v[16:17], v[16:17], v[148:149]
    v_exp_f32 v18, v16
    v_exp_f32 v19, v17
    s_nop 0
    v_pk_add_f32 v[18:19], v[18:19], v[12:13]
    v_rcp_f32 v18, v18
    v_rcp_f32 v19, v19
    s_nop 0
    v_pk_mul_f32 v[20:21], v[20:21], v[18:19]
    v_cvt_pk_bf16_f32 v26, v20, v21
    v_pk_mul_f32 v[14:15], v[150:151], v[150:151]
    v_pk_mul_f32 v[20:21], v[150:151], v[158:159]
    v_pk_fma_f32 v[16:17], v[14:15], v[10:11], v[8:9]
    v_pk_mul_f32 v[16:17], v[16:17], v[150:151]
    v_exp_f32 v18, v16
    v_exp_f32 v19, v17
    s_nop 0
    v_pk_add_f32 v[18:19], v[18:19], v[12:13]
    v_rcp_f32 v18, v18
    v_rcp_f32 v19, v19
    s_nop 0
    v_pk_mul_f32 v[20:21], v[20:21], v[18:19]
    v_cvt_pk_bf16_f32 v27, v20, v21
    buffer_store_dwordx4 v[24:27], v4, s[40:43], s24 offen offset:1024 sc1
    v_pk_mul_f32 v[14:15], v[240:241], v[240:241]
    v_pk_mul_f32 v[20:21], v[240:241], v[248:249]
    v_pk_fma_f32 v[16:17], v[14:15], v[10:11], v[8:9]
    v_pk_mul_f32 v[16:17], v[16:17], v[240:241]
    v_exp_f32 v18, v16
    v_exp_f32 v19, v17
    s_nop 0
    v_pk_add_f32 v[18:19], v[18:19], v[12:13]
    v_rcp_f32 v18, v18
    v_rcp_f32 v19, v19
    s_nop 0
    v_pk_mul_f32 v[20:21], v[20:21], v[18:19]
    v_cvt_pk_bf16_f32 v28, v20, v21
    v_pk_mul_f32 v[14:15], v[242:243], v[242:243]
    v_pk_mul_f32 v[20:21], v[242:243], v[250:251]
    v_pk_fma_f32 v[16:17], v[14:15], v[10:11], v[8:9]
    v_pk_mul_f32 v[16:17], v[16:17], v[242:243]
    v_exp_f32 v18, v16
    v_exp_f32 v19, v17
    s_nop 0
    v_pk_add_f32 v[18:19], v[18:19], v[12:13]
    v_rcp_f32 v18, v18
    v_rcp_f32 v19, v19
    s_nop 0
    v_pk_mul_f32 v[20:21], v[20:21], v[18:19]
    v_cvt_pk_bf16_f32 v29, v20, v21
    v_pk_mul_f32 v[14:15], v[244:245], v[244:245]
    v_pk_mul_f32 v[20:21], v[244:245], v[252:253]
    v_pk_fma_f32 v[16:17], v[14:15], v[10:11], v[8:9]
    v_pk_mul_f32 v[16:17], v[16:17], v[244:245]
    v_exp_f32 v18, v16
    v_exp_f32 v19, v17
    s_nop 0
    v_pk_add_f32 v[18:19], v[18:19], v[12:13]
    v_rcp_f32 v18, v18
    v_rcp_f32 v19, v19
    s_nop 0
    v_pk_mul_f32 v[20:21], v[20:21], v[18:19]
    v_cvt_pk_bf16_f32 v30, v20, v21
    v_pk_mul_f32 v[14:15], v[246:247], v[246:247]
    v_pk_mul_f32 v[20:21], v[246:247], v[254:255]
    v_pk_fma_f32 v[16:17], v[14:15], v[10:11], v[8:9]
    v_pk_mul_f32 v[16:17], v[16:17], v[246:247]
    v_exp_f32 v18, v16
    v_exp_f32 v19, v17
    s_nop 0
    v_pk_add_f32 v[18:19], v[18:19], v[12:13]
    v_rcp_f32 v18, v18
    v_rcp_f32 v19, v19
    s_nop 0
    v_pk_mul_f32 v[20:21], v[20:21], v[18:19]
    v_cvt_pk_bf16_f32 v31, v20, v21
    buffer_store_dwordx4 v[28:31], v4, s[40:43], s25 offen offset:1024 sc1
    s_branch gated_mix__mha_block__glu_gated_geglu__prompt_kernel_f6fin
gated_mix__mha_block__glu_gated_geglu__prompt_kernel_loader:
    s_sub_u32 s22, s22, 4
    v_mov_b32 v3, 162176
    v_mov_b32 v4, 0
    ds_write_b32 v3, v4
    s_lshl_b32 s64, s2, 2
    s_add_u32 s64, s64, s22
    s_mul_i32 s45, s20, 327680
    s_add_u32 s45, s45, 256
    s_cmp_eq_u32 s29, 3
    s_cbranch_scc1 gated_mix__mha_block__glu_gated_geglu__prompt_kernel_f6l
    s_cmp_eq_u32 s29, 4
    s_cbranch_scc1 gated_mix__mha_block__glu_gated_geglu__prompt_kernel_idlel
    s_mul_i32 s23, s22, 320
    v_add_u32 v3, s23, v2
    v_add_u32 v3, 0, v3
    v_mul_u32_u24 v4, 3277, v3
    v_lshrrev_b32 v4, 16, v4
    v_mul_u32_u24 v5, 20, v4
    v_sub_u32 v5, v3, v5
    v_mul_u32_u24 v4, 3840, v4
    v_lshl_add_u32 v16, v5, 4, v4
    v_add_u32 v3, s23, v2
    v_add_u32 v3, 64, v3
    v_mul_u32_u24 v4, 3277, v3
    v_lshrrev_b32 v4, 16, v4
    v_mul_u32_u24 v5, 20, v4
    v_sub_u32 v5, v3, v5
    v_mul_u32_u24 v4, 3840, v4
    v_lshl_add_u32 v17, v5, 4, v4
    v_add_u32 v3, s23, v2
    v_add_u32 v3, 128, v3
    v_mul_u32_u24 v4, 3277, v3
    v_lshrrev_b32 v4, 16, v4
    v_mul_u32_u24 v5, 20, v4
    v_sub_u32 v5, v3, v5
    v_mul_u32_u24 v4, 3840, v4
    v_lshl_add_u32 v18, v5, 4, v4
    v_add_u32 v3, s23, v2
    v_add_u32 v3, 192, v3
    v_mul_u32_u24 v4, 3277, v3
    v_lshrrev_b32 v4, 16, v4
    v_mul_u32_u24 v5, 20, v4
    v_sub_u32 v5, v3, v5
    v_mul_u32_u24 v4, 3840, v4
    v_lshl_add_u32 v19, v5, 4, v4
    v_add_u32 v3, s23, v2
    v_add_u32 v3, 256, v3
    v_mul_u32_u24 v4, 3277, v3
    v_lshrrev_b32 v4, 16, v4
    v_mul_u32_u24 v5, 20, v4
    v_sub_u32 v5, v3, v5
    v_mul_u32_u24 v4, 3840, v4
    v_lshl_add_u32 v20, v5, 4, v4
    s_lshl_b32 s61, s22, 13
    s_mul_i32 s62, s22, 5120
    s_add_u32 s62, s62, 32768
    s_lshl_b32 s63, s26, 6
    s_waitcnt lgkmcnt(0)
    s_mov_b32 s36, s6
    s_mov_b32 s37, s7
    s_lshl_b32 s46, s27, 1
    s_and_b32 s37, s37, 0xffff
    s_mul_i32 s38, s26, 640
    s_mov_b32 s39, 0x20000
    s_mov_b32 s44, 0
    s_add_u32 s23, s44, s62
    s_add_u32 m0, s23, 0
    s_nop 0
    buffer_load_dwordx4 v16, s[36:39], s46 offen lds
    s_add_u32 m0, s23, 1024
    s_nop 0
    buffer_load_dwordx4 v17, s[36:39], s46 offen lds
    s_add_u32 m0, s23, 2048
    s_nop 0
    buffer_load_dwordx4 v18, s[36:39], s46 offen lds
    s_add_u32 m0, s23, 3072
    s_nop 0
    buffer_load_dwordx4 v19, s[36:39], s46 offen lds
    s_add_u32 m0, s23, 4096
    s_nop 0
    buffer_load_dwordx4 v20, s[36:39], s46 offen lds
    s_add_u32 s46, s46, s63
    s_add_u32 s44, s44, 53376
    s_cmp_eq_u32 s44, 160128
    s_cselect_b32 s44, 0, s44
    s_add_u32 s23, s44, s62
    s_add_u32 m0, s23, 0
    s_nop 0
    buffer_load_dwordx4 v16, s[36:39], s46 offen lds
    s_add_u32 m0, s23, 1024
    s_nop 0
    buffer_load_dwordx4 v17, s[36:39], s46 offen lds
    s_add_u32 m0, s23, 2048
    s_nop 0
    buffer_load_dwordx4 v18, s[36:39], s46 offen lds
    s_add_u32 m0, s23, 3072
    s_nop 0
    buffer_load_dwordx4 v19, s[36:39], s46 offen lds
    s_add_u32 m0, s23, 4096
    s_nop 0
    buffer_load_dwordx4 v20, s[36:39], s46 offen lds
    s_add_u32 s46, s46, s63
    s_add_u32 s44, s44, 53376
    s_cmp_eq_u32 s44, 160128
    s_cselect_b32 s44, 0, s44
    s_mov_b32 s32, s4
    s_and_b32 s33, s5, 0xffff
    s_mov_b32 s34, 2621440
    s_mov_b32 s35, 0x20000
    s_mov_b32 s40, s48
    s_and_b32 s41, s49, 0xffff
    s_mov_b32 s42, 26214400
    s_mov_b32 s43, 0x20000
    v_lshrrev_b32 v3, 3, v2
    v_lshrrev_b32 v4, 4, v2
    v_and_b32 v5, 7, v2
    v_xor_b32 v5, v5, v4
    v_xor_b32 v6, 4, v5
    s_lshl_b32 s23, s22, 6
    v_add_u32 v3, s23, v3
    v_mul_u32_u24 v3, 1280, v3
    v_lshl_add_u32 v5, v5, 4, v3
    v_lshl_add_u32 v6, v6, 4, v3
    v_add_u32 v8, 0, v5
    v_add_u32 v9, 10240, v6
    v_add_u32 v10, 20480, v5
    v_add_u32 v11, 30720, v6
    v_add_u32 v12, 40960, v5
    v_add_u32 v13, 51200, v6
    v_add_u32 v14, 61440, v5
    v_add_u32 v15, 71680, v6
    s_waitcnt vmcnt(5)
    s_barrier
    s_add_u32 s23, s44, s62
    s_add_u32 m0, s23, 0
    s_nop 0
    buffer_load_dwordx4 v16, s[36:39], s46 offen lds
    s_add_u32 m0, s23, 1024
    s_nop 0
    buffer_load_dwordx4 v17, s[36:39], s46 offen lds
    s_add_u32 m0, s23, 2048
    s_nop 0
    buffer_load_dwordx4 v18, s[36:39], s46 offen lds
    s_add_u32 m0, s23, 3072
    s_nop 0
    buffer_load_dwordx4 v19, s[36:39], s46 offen lds
    s_add_u32 m0, s23, 4096
    s_nop 0
    buffer_load_dwordx4 v20, s[36:39], s46 offen lds
    s_add_u32 s46, s46, s63
    s_add_u32 s23, s44, s61
    s_add_u32 m0, s23, 0
    s_nop 0
    buffer_load_dwordx4 v8, s[32:35], s45 offen lds
    s_add_u32 m0, s23, 1024
    s_nop 0
    buffer_load_dwordx4 v9, s[32:35], s45 offen lds
    s_add_u32 m0, s23, 2048
    s_nop 0
    buffer_load_dwordx4 v10, s[32:35], s45 offen lds
    s_add_u32 m0, s23, 3072
    s_nop 0
    buffer_load_dwordx4 v11, s[32:35], s45 offen lds
    s_add_u32 m0, s23, 4096
    s_nop 0
    buffer_load_dwordx4 v12, s[32:35], s45 offen lds
    s_add_u32 m0, s23, 5120
    s_nop 0
    buffer_load_dwordx4 v13, s[32:35], s45 offen lds
    s_add_u32 m0, s23, 6144
    s_nop 0
    buffer_load_dwordx4 v14, s[32:35], s45 offen lds
    s_add_u32 m0, s23, 7168
    s_nop 0
    buffer_load_dwordx4 v15, s[32:35], s45 offen lds
    s_add_u32 s45, s45, 128
    s_add_u32 s44, s44, 53376
    s_cmp_eq_u32 s44, 160128
    s_cselect_b32 s44, 0, s44
    s_waitcnt vmcnt(13)
    s_barrier
    s_add_u32 s23, s44, s62
    s_add_u32 m0, s23, 0
    s_nop 0
    buffer_load_dwordx4 v16, s[36:39], s46 offen lds
    s_add_u32 m0, s23, 1024
    s_nop 0
    buffer_load_dwordx4 v17, s[36:39], s46 offen lds
    s_add_u32 m0, s23, 2048
    s_nop 0
    buffer_load_dwordx4 v18, s[36:39], s46 offen lds
    s_add_u32 m0, s23, 3072
    s_nop 0
    buffer_load_dwordx4 v19, s[36:39], s46 offen lds
    s_add_u32 m0, s23, 4096
    s_nop 0
    buffer_load_dwordx4 v20, s[36:39], s46 offen lds
    s_add_u32 s46, s46, s63
    s_add_u32 s23, s44, s61
    s_add_u32 m0, s23, 0
    s_nop 0
    buffer_load_dwordx4 v8, s[32:35], s45 offen lds
    s_add_u32 m0, s23, 1024
    s_nop 0
    buffer_load_dwordx4 v9, s[32:35], s45 offen lds
    s_add_u32 m0, s23, 2048
    s_nop 0
    buffer_load_dwordx4 v10, s[32:35], s45 offen lds
    s_add_u32 m0, s23, 3072
    s_nop 0
    buffer_load_dwordx4 v11, s[32:35], s45 offen lds
    s_add_u32 m0, s23, 4096
    s_nop 0
    buffer_load_dwordx4 v12, s[32:35], s45 offen lds
    s_add_u32 m0, s23, 5120
    s_nop 0
    buffer_load_dwordx4 v13, s[32:35], s45 offen lds
    s_add_u32 m0, s23, 6144
    s_nop 0
    buffer_load_dwordx4 v14, s[32:35], s45 offen lds
    s_add_u32 m0, s23, 7168
    s_nop 0
    buffer_load_dwordx4 v15, s[32:35], s45 offen lds
    s_add_u32 s45, s45, 128
    s_add_u32 s44, s44, 53376
    s_cmp_eq_u32 s44, 160128
    s_cselect_b32 s44, 0, s44
    s_waitcnt vmcnt(13)
    s_barrier
    s_add_u32 s23, s44, s62
    s_add_u32 m0, s23, 0
    s_nop 0
    buffer_load_dwordx4 v16, s[36:39], s46 offen lds
    s_add_u32 m0, s23, 1024
    s_nop 0
    buffer_load_dwordx4 v17, s[36:39], s46 offen lds
    s_add_u32 m0, s23, 2048
    s_nop 0
    buffer_load_dwordx4 v18, s[36:39], s46 offen lds
    s_add_u32 m0, s23, 3072
    s_nop 0
    buffer_load_dwordx4 v19, s[36:39], s46 offen lds
    s_add_u32 m0, s23, 4096
    s_nop 0
    buffer_load_dwordx4 v20, s[36:39], s46 offen lds
    s_add_u32 s46, s46, s63
    s_add_u32 s23, s44, s61
    s_add_u32 m0, s23, 0
    s_nop 0
    buffer_load_dwordx4 v8, s[32:35], s45 offen lds
    s_add_u32 m0, s23, 1024
    s_nop 0
    buffer_load_dwordx4 v9, s[32:35], s45 offen lds
    s_add_u32 m0, s23, 2048
    s_nop 0
    buffer_load_dwordx4 v10, s[32:35], s45 offen lds
    s_add_u32 m0, s23, 3072
    s_nop 0
    buffer_load_dwordx4 v11, s[32:35], s45 offen lds
    s_add_u32 m0, s23, 4096
    s_nop 0
    buffer_load_dwordx4 v12, s[32:35], s45 offen lds
    s_add_u32 m0, s23, 5120
    s_nop 0
    buffer_load_dwordx4 v13, s[32:35], s45 offen lds
    s_add_u32 m0, s23, 6144
    s_nop 0
    buffer_load_dwordx4 v14, s[32:35], s45 offen lds
    s_add_u32 m0, s23, 7168
    s_nop 0
    buffer_load_dwordx4 v15, s[32:35], s45 offen lds
    s_add_u32 s45, s45, 128
    s_add_u32 s44, s44, 53376
    s_cmp_eq_u32 s44, 160128
    s_cselect_b32 s44, 0, s44
    s_waitcnt vmcnt(13)
    s_barrier
    s_add_u32 s23, s44, s62
    s_add_u32 m0, s23, 0
    s_nop 0
    buffer_load_dwordx4 v16, s[36:39], s46 offen lds
    s_add_u32 m0, s23, 1024
    s_nop 0
    buffer_load_dwordx4 v17, s[36:39], s46 offen lds
    s_add_u32 m0, s23, 2048
    s_nop 0
    buffer_load_dwordx4 v18, s[36:39], s46 offen lds
    s_add_u32 m0, s23, 3072
    s_nop 0
    buffer_load_dwordx4 v19, s[36:39], s46 offen lds
    s_add_u32 m0, s23, 4096
    s_nop 0
    buffer_load_dwordx4 v20, s[36:39], s46 offen lds
    s_add_u32 s46, s46, s63
    s_add_u32 s23, s44, s61
    s_add_u32 m0, s23, 0
    s_nop 0
    buffer_load_dwordx4 v8, s[32:35], s45 offen lds
    s_add_u32 m0, s23, 1024
    s_nop 0
    buffer_load_dwordx4 v9, s[32:35], s45 offen lds
    s_add_u32 m0, s23, 2048
    s_nop 0
    buffer_load_dwordx4 v10, s[32:35], s45 offen lds
    s_add_u32 m0, s23, 3072
    s_nop 0
    buffer_load_dwordx4 v11, s[32:35], s45 offen lds
    s_add_u32 m0, s23, 4096
    s_nop 0
    buffer_load_dwordx4 v12, s[32:35], s45 offen lds
    s_add_u32 m0, s23, 5120
    s_nop 0
    buffer_load_dwordx4 v13, s[32:35], s45 offen lds
    s_add_u32 m0, s23, 6144
    s_nop 0
    buffer_load_dwordx4 v14, s[32:35], s45 offen lds
    s_add_u32 m0, s23, 7168
    s_nop 0
    buffer_load_dwordx4 v15, s[32:35], s45 offen lds
    s_add_u32 s45, s45, 128
    s_add_u32 s44, s44, 53376
    s_cmp_eq_u32 s44, 160128
    s_cselect_b32 s44, 0, s44
    s_waitcnt vmcnt(13)
    s_barrier
    s_add_u32 s23, s44, s62
    s_add_u32 m0, s23, 0
    s_nop 0
    buffer_load_dwordx4 v16, s[36:39], s46 offen lds
    s_add_u32 m0, s23, 1024
    s_nop 0
    buffer_load_dwordx4 v17, s[36:39], s46 offen lds
    s_add_u32 m0, s23, 2048
    s_nop 0
    buffer_load_dwordx4 v18, s[36:39], s46 offen lds
    s_add_u32 m0, s23, 3072
    s_nop 0
    buffer_load_dwordx4 v19, s[36:39], s46 offen lds
    s_add_u32 m0, s23, 4096
    s_nop 0
    buffer_load_dwordx4 v20, s[36:39], s46 offen lds
    s_add_u32 s46, s46, s63
    s_add_u32 s23, s44, s61
    s_add_u32 m0, s23, 0
    s_nop 0
    buffer_load_dwordx4 v8, s[32:35], s45 offen lds
    s_add_u32 m0, s23, 1024
    s_nop 0
    buffer_load_dwordx4 v9, s[32:35], s45 offen lds
    s_add_u32 m0, s23, 2048
    s_nop 0
    buffer_load_dwordx4 v10, s[32:35], s45 offen lds
    s_add_u32 m0, s23, 3072
    s_nop 0
    buffer_load_dwordx4 v11, s[32:35], s45 offen lds
    s_add_u32 m0, s23, 4096
    s_nop 0
    buffer_load_dwordx4 v12, s[32:35], s45 offen lds
    s_add_u32 m0, s23, 5120
    s_nop 0
    buffer_load_dwordx4 v13, s[32:35], s45 offen lds
    s_add_u32 m0, s23, 6144
    s_nop 0
    buffer_load_dwordx4 v14, s[32:35], s45 offen lds
    s_add_u32 m0, s23, 7168
    s_nop 0
    buffer_load_dwordx4 v15, s[32:35], s45 offen lds
    s_add_u32 s45, s45, 128
    s_add_u32 s44, s44, 53376
    s_cmp_eq_u32 s44, 160128
    s_cselect_b32 s44, 0, s44
    s_waitcnt vmcnt(13)
    s_barrier
    s_add_u32 s23, s44, s62
    s_add_u32 m0, s23, 0
    s_nop 0
    buffer_load_dwordx4 v16, s[36:39], s46 offen lds
    s_add_u32 m0, s23, 1024
    s_nop 0
    buffer_load_dwordx4 v17, s[36:39], s46 offen lds
    s_add_u32 m0, s23, 2048
    s_nop 0
    buffer_load_dwordx4 v18, s[36:39], s46 offen lds
    s_add_u32 m0, s23, 3072
    s_nop 0
    buffer_load_dwordx4 v19, s[36:39], s46 offen lds
    s_add_u32 m0, s23, 4096
    s_nop 0
    buffer_load_dwordx4 v20, s[36:39], s46 offen lds
    s_add_u32 s46, s46, s63
    s_add_u32 s23, s44, s61
    s_add_u32 m0, s23, 0
    s_nop 0
    buffer_load_dwordx4 v8, s[32:35], s45 offen lds
    s_add_u32 m0, s23, 1024
    s_nop 0
    buffer_load_dwordx4 v9, s[32:35], s45 offen lds
    s_add_u32 m0, s23, 2048
    s_nop 0
    buffer_load_dwordx4 v10, s[32:35], s45 offen lds
    s_add_u32 m0, s23, 3072
    s_nop 0
    buffer_load_dwordx4 v11, s[32:35], s45 offen lds
    s_add_u32 m0, s23, 4096
    s_nop 0
    buffer_load_dwordx4 v12, s[32:35], s45 offen lds
    s_add_u32 m0, s23, 5120
    s_nop 0
    buffer_load_dwordx4 v13, s[32:35], s45 offen lds
    s_add_u32 m0, s23, 6144
    s_nop 0
    buffer_load_dwordx4 v14, s[32:35], s45 offen lds
    s_add_u32 m0, s23, 7168
    s_nop 0
    buffer_load_dwordx4 v15, s[32:35], s45 offen lds
    s_add_u32 s45, s45, 128
    s_add_u32 s44, s44, 53376
    s_cmp_eq_u32 s44, 160128
    s_cselect_b32 s44, 0, s44
    s_waitcnt vmcnt(13)
    s_barrier
    s_add_u32 s23, s44, s62
    s_add_u32 m0, s23, 0
    s_nop 0
    buffer_load_dwordx4 v16, s[36:39], s46 offen lds
    s_add_u32 m0, s23, 1024
    s_nop 0
    buffer_load_dwordx4 v17, s[36:39], s46 offen lds
    s_add_u32 m0, s23, 2048
    s_nop 0
    buffer_load_dwordx4 v18, s[36:39], s46 offen lds
    s_add_u32 m0, s23, 3072
    s_nop 0
    buffer_load_dwordx4 v19, s[36:39], s46 offen lds
    s_add_u32 m0, s23, 4096
    s_nop 0
    buffer_load_dwordx4 v20, s[36:39], s46 offen lds
    s_add_u32 s46, s46, s63
    s_add_u32 s23, s44, s61
    s_add_u32 m0, s23, 0
    s_nop 0
    buffer_load_dwordx4 v8, s[32:35], s45 offen lds
    s_add_u32 m0, s23, 1024
    s_nop 0
    buffer_load_dwordx4 v9, s[32:35], s45 offen lds
    s_add_u32 m0, s23, 2048
    s_nop 0
    buffer_load_dwordx4 v10, s[32:35], s45 offen lds
    s_add_u32 m0, s23, 3072
    s_nop 0
    buffer_load_dwordx4 v11, s[32:35], s45 offen lds
    s_add_u32 m0, s23, 4096
    s_nop 0
    buffer_load_dwordx4 v12, s[32:35], s45 offen lds
    s_add_u32 m0, s23, 5120
    s_nop 0
    buffer_load_dwordx4 v13, s[32:35], s45 offen lds
    s_add_u32 m0, s23, 6144
    s_nop 0
    buffer_load_dwordx4 v14, s[32:35], s45 offen lds
    s_add_u32 m0, s23, 7168
    s_nop 0
    buffer_load_dwordx4 v15, s[32:35], s45 offen lds
    s_add_u32 s45, s45, 128
    s_add_u32 s44, s44, 53376
    s_cmp_eq_u32 s44, 160128
    s_cselect_b32 s44, 0, s44
    s_waitcnt vmcnt(13)
    s_barrier
    s_add_u32 s23, s44, s62
    s_add_u32 m0, s23, 0
    s_nop 0
    buffer_load_dwordx4 v16, s[36:39], s46 offen lds
    s_add_u32 m0, s23, 1024
    s_nop 0
    buffer_load_dwordx4 v17, s[36:39], s46 offen lds
    s_add_u32 m0, s23, 2048
    s_nop 0
    buffer_load_dwordx4 v18, s[36:39], s46 offen lds
    s_add_u32 m0, s23, 3072
    s_nop 0
    buffer_load_dwordx4 v19, s[36:39], s46 offen lds
    s_add_u32 m0, s23, 4096
    s_nop 0
    buffer_load_dwordx4 v20, s[36:39], s46 offen lds
    s_add_u32 s46, s46, s63
    s_add_u32 s23, s44, s61
    s_add_u32 m0, s23, 0
    s_nop 0
    buffer_load_dwordx4 v8, s[32:35], s45 offen lds
    s_add_u32 m0, s23, 1024
    s_nop 0
    buffer_load_dwordx4 v9, s[32:35], s45 offen lds
    s_add_u32 m0, s23, 2048
    s_nop 0
    buffer_load_dwordx4 v10, s[32:35], s45 offen lds
    s_add_u32 m0, s23, 3072
    s_nop 0
    buffer_load_dwordx4 v11, s[32:35], s45 offen lds
    s_add_u32 m0, s23, 4096
    s_nop 0
    buffer_load_dwordx4 v12, s[32:35], s45 offen lds
    s_add_u32 m0, s23, 5120
    s_nop 0
    buffer_load_dwordx4 v13, s[32:35], s45 offen lds
    s_add_u32 m0, s23, 6144
    s_nop 0
    buffer_load_dwordx4 v14, s[32:35], s45 offen lds
    s_add_u32 m0, s23, 7168
    s_nop 0
    buffer_load_dwordx4 v15, s[32:35], s45 offen lds
    s_add_u32 s45, s45, 128
    s_add_u32 s44, s44, 53376
    s_cmp_eq_u32 s44, 160128
    s_cselect_b32 s44, 0, s44
    s_load_dwordx2 s[92:93], s[0:1], 72
    s_waitcnt lgkmcnt(0)
    s_mov_b32 s88, s92
    s_and_b32 s89, s93, 0xffff
    s_mov_b32 s90, 256
    s_mov_b32 s91, 0x20000
    v_mov_b32 v131, 240
    buffer_load_dword v130, v131, s[88:91], 0 offen sc1
    s_waitcnt vmcnt(14)
    s_barrier
    s_waitcnt vmcnt(1)
    s_barrier
    s_cmp_eq_u32 s29, 2
    s_cbranch_scc0 gated_mix__mha_block__glu_gated_geglu__prompt_kernel_novp
    v_and_b32 v3, 15, v2
    v_add_u32 v3, 16, v3
    v_lshrrev_b32 v4, 4, v2
    v_lshlrev_b32 v4, 9, v4
    v_lshl_add_u32 v4, v3, 4, v4
    v_cmp_gt_u32 vcc, 20, v3
    v_mov_b32 v5, 0x7ff00000
    v_mov_b32 v124, 0x3f803f80
    v_cndmask_b32 v4, v4, v5, vcc
    v_cmp_eq_u32 vcc, 20, v3
    s_nop 1
    v_cndmask_b32 v124, 0, v124, vcc
    s_nop 0
    v_mov_b32 v125, v124
    v_mov_b32 v126, v124
    v_mov_b32 v127, v124
    s_sub_u32 s23, s21, 8
    s_lshl_b32 s23, s23, 3
    s_lshl_b32 s24, s22, 1
    s_add_u32 s23, s23, s24
    s_mul_i32 s23, s23, 212992
    s_lshl_b32 s24, s20, 1
    s_mul_i32 s24, s24, 13312
    s_add_u32 s23, s23, s24
    s_add_u32 s23, s23, 2626560
    s_add_u32 s24, s23, 0
    buffer_store_dwordx4 v[124:127], v4, s[40:43], s24 offen sc1
    s_add_u32 s24, s23, 2048
    buffer_store_dwordx4 v[124:127], v4, s[40:43], s24 offen sc1
    s_add_u32 s24, s23, 4096
    buffer_store_dwordx4 v[124:127], v4, s[40:43], s24 offen sc1
    s_add_u32 s24, s23, 6144
    buffer_store_dwordx4 v[124:127], v4, s[40:43], s24 offen sc1
    s_add_u32 s24, s23, 13312
    buffer_store_dwordx4 v[124:127], v4, s[40:43], s24 offen sc1
    s_add_u32 s24, s23, 15360
    buffer_store_dwordx4 v[124:127], v4, s[40:43], s24 offen sc1
    s_add_u32 s24, s23, 17408
    buffer_store_dwordx4 v[124:127], v4, s[40:43], s24 offen sc1
    s_add_u32 s24, s23, 19456
    buffer_store_dwordx4 v[124:127], v4, s[40:43], s24 offen sc1
    s_add_u32 s24, s23, 212992
    buffer_store_dwordx4 v[124:127], v4, s[40:43], s24 offen sc1
    s_add_u32 s24, s23, 215040
    buffer_store_dwordx4 v[124:127], v4, s[40:43], s24 offen sc1
    s_add_u32 s24, s23, 217088
    buffer_store_dwordx4 v[124:127], v4, s[40:43], s24 offen sc1
    s_add_u32 s24, s23, 219136
    buffer_store_dwordx4 v[124:127], v4, s[40:43], s24 offen sc1
    s_add_u32 s24, s23, 226304
    buffer_store_dwordx4 v[124:127], v4, s[40:43], s24 offen sc1
    s_add_u32 s24, s23, 228352
    buffer_store_dwordx4 v[124:127], v4, s[40:43], s24 offen sc1
    s_add_u32 s24, s23, 230400
    buffer_store_dwordx4 v[124:127], v4, s[40:43], s24 offen sc1
    s_add_u32 s24, s23, 232448
    buffer_store_dwordx4 v[124:127], v4, s[40:43], s24 offen sc1
gated_mix__mha_block__glu_gated_geglu__prompt_kernel_novp:
    s_barrier
    s_branch gated_mix__mha_block__glu_gated_geglu__prompt_kernel_fin
gated_mix__mha_block__glu_gated_geglu__prompt_kernel_f6l:
    s_and_b32 s23, s22, 1
    s_mul_i32 s23, s23, 192
    v_add_u32 v3, s23, v2
    v_add_u32 v3, 0, v3
    v_mul_u32_u24 v4, 5462, v3
    v_lshrrev_b32 v4, 16, v4
    v_mul_u32_u24 v5, 12, v4
    v_sub_u32 v5, v3, v5
    v_mul_u32_u24 v4, 3072, v4
    v_lshl_add_u32 v16, v5, 4, v4
    v_add_u32 v3, s23, v2
    v_add_u32 v3, 64, v3
    v_mul_u32_u24 v4, 5462, v3
    v_lshrrev_b32 v4, 16, v4
    v_mul_u32_u24 v5, 12, v4
    v_sub_u32 v5, v3, v5
    v_mul_u32_u24 v4, 3072, v4
    v_lshl_add_u32 v17, v5, 4, v4
    v_add_u32 v3, s23, v2
    v_add_u32 v3, 128, v3
    v_mul_u32_u24 v4, 5462, v3
    v_lshrrev_b32 v4, 16, v4
    v_mul_u32_u24 v5, 12, v4
    v_sub_u32 v5, v3, v5
    v_mul_u32_u24 v4, 3072, v4
    v_lshl_add_u32 v18, v5, 4, v4
    s_lshl_b32 s61, s22, 13
    s_lshr_b32 s23, s22, 1
    s_mul_i32 s62, s23, 6176
    s_and_b32 s23, s22, 1
    s_mul_i32 s23, s23, 3072
    s_add_u32 s62, s62, s23
    s_add_u32 s62, s62, 98304
    s_mul_i32 s46, s21, 192
    s_waitcnt lgkmcnt(0)
    s_cmp_ge_u32 s22, 2
    s_cselect_b32 s36, s14, s12
    s_cselect_b32 s37, s15, s13
    s_and_b32 s37, s37, 0xffff
    s_mov_b32 s38, 1966080
    s_mov_b32 s39, 0x20000
    s_add_u32 m0, s62, 0
    s_nop 0
    buffer_load_dwordx4 v16, s[36:39], s46 offen lds
    s_add_u32 m0, s62, 1024
    s_nop 0
    buffer_load_dwordx4 v17, s[36:39], s46 offen lds
    s_add_u32 m0, s62, 2048
    s_nop 0
    buffer_load_dwordx4 v18, s[36:39], s46 offen lds
    s_add_u32 s46, s46, 98304
    s_add_u32 m0, s62, 12320
    s_nop 0
    buffer_load_dwordx4 v16, s[36:39], s46 offen lds
    s_add_u32 m0, s62, 13344
    s_nop 0
    buffer_load_dwordx4 v17, s[36:39], s46 offen lds
    s_add_u32 m0, s62, 14368
    s_nop 0
    buffer_load_dwordx4 v18, s[36:39], s46 offen lds
    s_add_u32 s46, s46, 98304
    s_mov_b32 s32, s4
    s_and_b32 s33, s5, 0xffff
    s_mov_b32 s34, 2621440
    s_mov_b32 s35, 0x20000
    s_mov_b32 s40, s48
    s_and_b32 s41, s49, 0xffff
    s_mov_b32 s42, 26214400
    s_mov_b32 s43, 0x20000
    v_lshrrev_b32 v3, 3, v2
    v_lshrrev_b32 v4, 4, v2
    v_and_b32 v5, 7, v2
    v_xor_b32 v5, v5, v4
    v_xor_b32 v6, 4, v5
    s_lshl_b32 s23, s22, 6
    v_add_u32 v3, s23, v3
    v_mul_u32_u24 v3, 1280, v3
    v_lshl_add_u32 v5, v5, 4, v3
    v_lshl_add_u32 v6, v6, 4, v3
    v_add_u32 v8, 0, v5
    v_add_u32 v9, 10240, v6
    v_add_u32 v10, 20480, v5
    v_add_u32 v11, 30720, v6
    v_add_u32 v12, 40960, v5
    v_add_u32 v13, 51200, v6
    v_add_u32 v14, 61440, v5
    v_add_u32 v15, 71680, v6
    s_add_u32 m0, s62, 24640
    s_nop 0
    buffer_load_dwordx4 v16, s[36:39], s46 offen lds
    s_add_u32 m0, s62, 25664
    s_nop 0
    buffer_load_dwordx4 v17, s[36:39], s46 offen lds
    s_add_u32 m0, s62, 26688
    s_nop 0
    buffer_load_dwordx4 v18, s[36:39], s46 offen lds
    s_add_u32 s46, s46, 98304
    s_add_u32 m0, s62, 36960
    s_nop 0
    buffer_load_dwordx4 v16, s[36:39], s46 offen lds
    s_add_u32 m0, s62, 37984
    s_nop 0
    buffer_load_dwordx4 v17, s[36:39], s46 offen lds
    s_add_u32 m0, s62, 39008
    s_nop 0
    buffer_load_dwordx4 v18, s[36:39], s46 offen lds
    s_add_u32 s46, s46, 98304
    s_add_u32 m0, s61, 65536
    s_nop 0
    buffer_load_dwordx4 v8, s[32:35], s45 offen lds
    s_add_u32 m0, s61, 66560
    s_nop 0
    buffer_load_dwordx4 v9, s[32:35], s45 offen lds
    s_add_u32 m0, s61, 67584
    s_nop 0
    buffer_load_dwordx4 v10, s[32:35], s45 offen lds
    s_add_u32 m0, s61, 68608
    s_nop 0
    buffer_load_dwordx4 v11, s[32:35], s45 offen lds
    s_add_u32 m0, s61, 69632
    s_nop 0
    buffer_load_dwordx4 v12, s[32:35], s45 offen lds
    s_add_u32 m0, s61, 70656
    s_nop 0
    buffer_load_dwordx4 v13, s[32:35], s45 offen lds
    s_add_u32 m0, s61, 71680
    s_nop 0
    buffer_load_dwordx4 v14, s[32:35], s45 offen lds
    s_add_u32 m0, s61, 72704
    s_nop 0
    buffer_load_dwordx4 v15, s[32:35], s45 offen lds
    s_add_u32 s45, s45, 128
    s_waitcnt vmcnt(17)
    s_barrier
    v_lshlrev_b32 v21, 4, v2
    s_mov_b32 s68, s4
    s_and_b32 s69, s5, 0xffff
    s_mov_b32 s70, 2621440
    s_mov_b32 s71, 0x20000
    s_mov_b32 s72, s6
    s_and_b32 s73, s7, 0xffff
    s_mov_b32 s74, 2457600
    s_mov_b32 s75, 0x20000
    s_mov_b32 s76, s12
    s_and_b32 s77, s13, 0xffff
    s_mov_b32 s78, 1966080
    s_mov_b32 s79, 0x20000
    s_mov_b32 s80, s14
    s_and_b32 s81, s15, 0xffff
    s_mov_b32 s82, 1966080
    s_mov_b32 s83, 0x20000
    s_sub_u32 s24, s2, 96
    s_lshl_b32 s24, s24, 2
    s_add_u32 s24, s24, s22
    s_lshl_b32 s24, s24, 10
    v_add_u32 v21, s24, v21
    v_add_u32 v22, 655360, v21
    v_add_u32 v23, 1310720, v21
    v_add_u32 v24, 1966080, v21
    s_waitcnt vmcnt(14)
    s_barrier
    s_add_u32 m0, s62, 49280
    s_nop 0
    buffer_load_dwordx4 v16, s[36:39], s46 offen lds
    s_add_u32 m0, s62, 50304
    s_nop 0
    buffer_load_dwordx4 v17, s[36:39], s46 offen lds
    s_add_u32 m0, s62, 51328
    s_nop 0
    buffer_load_dwordx4 v18, s[36:39], s46 offen lds
    s_add_u32 s46, s46, 98304
    buffer_load_dwordx4 v[60:63], v21, s[72:75], 0 offen
    buffer_load_dwordx4 v[60:63], v21, s[76:79], 0 offen
    buffer_load_dwordx4 v[60:63], v21, s[80:83], 0 offen
    buffer_load_dwordx4 v[60:63], v21, s[68:71], 0 offen
    buffer_load_dwordx4 v[60:63], v22, s[68:71], 0 offen
    buffer_load_dwordx4 v[60:63], v22, s[72:75], 0 offen
    buffer_load_dwordx4 v[60:63], v22, s[76:79], 0 offen
    buffer_load_dwordx4 v[60:63], v22, s[80:83], 0 offen
    buffer_load_dwordx4 v[60:63], v23, s[68:71], 0 offen
    buffer_load_dwordx4 v[60:63], v24, s[68:71], 0 offen
    buffer_load_dwordx4 v[60:63], v23, s[72:75], 0 offen
    buffer_load_dwordx4 v[60:63], v23, s[76:79], 0 offen
    buffer_load_dwordx4 v[60:63], v23, s[80:83], 0 offen
    buffer_load_dwordx4 v[60:63], v24, s[72:75], 0 offen
    s_waitcnt vmcnt(28)
    s_barrier
    s_add_u32 m0, s62, 0
    s_nop 0
    buffer_load_dwordx4 v16, s[36:39], s46 offen lds
    s_add_u32 m0, s62, 1024
    s_nop 0
    buffer_load_dwordx4 v17, s[36:39], s46 offen lds
    s_add_u32 m0, s62, 2048
    s_nop 0
    buffer_load_dwordx4 v18, s[36:39], s46 offen lds
    s_add_u32 s46, s46, 98304
    s_add_u32 m0, s61, 0
    s_nop 0
    buffer_load_dwordx4 v8, s[32:35], s45 offen lds
    s_add_u32 m0, s61, 1024
    s_nop 0
    buffer_load_dwordx4 v9, s[32:35], s45 offen lds
    s_add_u32 m0, s61, 2048
    s_nop 0
    buffer_load_dwordx4 v10, s[32:35], s45 offen lds
    s_add_u32 m0, s61, 3072
    s_nop 0
    buffer_load_dwordx4 v11, s[32:35], s45 offen lds
    s_add_u32 m0, s61, 4096
    s_nop 0
    buffer_load_dwordx4 v12, s[32:35], s45 offen lds
    s_add_u32 m0, s61, 5120
    s_nop 0
    buffer_load_dwordx4 v13, s[32:35], s45 offen lds
    s_add_u32 m0, s61, 6144
    s_nop 0
    buffer_load_dwordx4 v14, s[32:35], s45 offen lds
    s_add_u32 m0, s61, 7168
    s_nop 0
    buffer_load_dwordx4 v15, s[32:35], s45 offen lds
    s_add_u32 s45, s45, 128
    s_waitcnt vmcnt(36)
    s_barrier
    s_add_u32 m0, s62, 12320
    s_nop 0
    buffer_load_dwordx4 v16, s[36:39], s46 offen lds
    s_add_u32 m0, s62, 13344
    s_nop 0
    buffer_load_dwordx4 v17, s[36:39], s46 offen lds
    s_add_u32 m0, s62, 14368
    s_nop 0
    buffer_load_dwordx4 v18, s[36:39], s46 offen lds
    s_add_u32 s46, s46, 98304
    s_waitcnt vmcnt(28)
    s_barrier
    s_add_u32 m0, s62, 24640
    s_nop 0
    buffer_load_dwordx4 v16, s[36:39], s46 offen lds
    s_add_u32 m0, s62, 25664
    s_nop 0
    buffer_load_dwordx4 v17, s[36:39], s46 offen lds
    s_add_u32 m0, s62, 26688
    s_nop 0
    buffer_load_dwordx4 v18, s[36:39], s46 offen lds
    s_add_u32 s46, s46, 98304
    s_add_u32 m0, s61, 32768
    s_nop 0
    buffer_load_dwordx4 v8, s[32:35], s45 offen lds
    s_add_u32 m0, s61, 33792
    s_nop 0
    buffer_load_dwordx4 v9, s[32:35], s45 offen lds
    s_add_u32 m0, s61, 34816
    s_nop 0
    buffer_load_dwordx4 v10, s[32:35], s45 offen lds
    s_add_u32 m0, s61, 35840
    s_nop 0
    buffer_load_dwordx4 v11, s[32:35], s45 offen lds
    s_add_u32 m0, s61, 36864
    s_nop 0
    buffer_load_dwordx4 v12, s[32:35], s45 offen lds
    s_add_u32 m0, s61, 37888
    s_nop 0
    buffer_load_dwordx4 v13, s[32:35], s45 offen lds
    s_add_u32 m0, s61, 38912
    s_nop 0
    buffer_load_dwordx4 v14, s[32:35], s45 offen lds
    s_add_u32 m0, s61, 39936
    s_nop 0
    buffer_load_dwordx4 v15, s[32:35], s45 offen lds
    s_add_u32 s45, s45, 128
    s_waitcnt vmcnt(22)
    s_barrier
    s_add_u32 m0, s62, 36960
    s_nop 0
    buffer_load_dwordx4 v16, s[36:39], s46 offen lds
    s_add_u32 m0, s62, 37984
    s_nop 0
    buffer_load_dwordx4 v17, s[36:39], s46 offen lds
    s_add_u32 m0, s62, 39008
    s_nop 0
    buffer_load_dwordx4 v18, s[36:39], s46 offen lds
    s_add_u32 s46, s46, 98304
    s_waitcnt vmcnt(14)
    s_barrier
    s_add_u32 m0, s62, 49280
    s_nop 0
    buffer_load_dwordx4 v16, s[36:39], s46 offen lds
    s_add_u32 m0, s62, 50304
    s_nop 0
    buffer_load_dwordx4 v17, s[36:39], s46 offen lds
    s_add_u32 m0, s62, 51328
    s_nop 0
    buffer_load_dwordx4 v18, s[36:39], s46 offen lds
    s_add_u32 s46, s46, 98304
    s_add_u32 m0, s61, 65536
    s_nop 0
    buffer_load_dwordx4 v8, s[32:35], s45 offen lds
    s_add_u32 m0, s61, 66560
    s_nop 0
    buffer_load_dwordx4 v9, s[32:35], s45 offen lds
    s_add_u32 m0, s61, 67584
    s_nop 0
    buffer_load_dwordx4 v10, s[32:35], s45 offen lds
    s_add_u32 m0, s61, 68608
    s_nop 0
    buffer_load_dwordx4 v11, s[32:35], s45 offen lds
    s_add_u32 m0, s61, 69632
    s_nop 0
    buffer_load_dwordx4 v12, s[32:35], s45 offen lds
    s_add_u32 m0, s61, 70656
    s_nop 0
    buffer_load_dwordx4 v13, s[32:35], s45 offen lds
    s_add_u32 m0, s61, 71680
    s_nop 0
    buffer_load_dwordx4 v14, s[32:35], s45 offen lds
    s_add_u32 m0, s61, 72704
    s_nop 0
    buffer_load_dwordx4 v15, s[32:35], s45 offen lds
    s_add_u32 s45, s45, 128
    s_waitcnt vmcnt(22)
    s_barrier
    s_add_u32 m0, s62, 0
    s_nop 0
    buffer_load_dwordx4 v16, s[36:39], s46 offen lds
    s_add_u32 m0, s62, 1024
    s_nop 0
    buffer_load_dwordx4 v17, s[36:39], s46 offen lds
    s_add_u32 m0, s62, 2048
    s_nop 0
    buffer_load_dwordx4 v18, s[36:39], s46 offen lds
    s_add_u32 s46, s46, 98304
    s_waitcnt vmcnt(14)
    s_barrier
    s_add_u32 m0, s62, 12320
    s_nop 0
    buffer_load_dwordx4 v16, s[36:39], s46 offen lds
    s_add_u32 m0, s62, 13344
    s_nop 0
    buffer_load_dwordx4 v17, s[36:39], s46 offen lds
    s_add_u32 m0, s62, 14368
    s_nop 0
    buffer_load_dwordx4 v18, s[36:39], s46 offen lds
    s_add_u32 s46, s46, 98304
    s_add_u32 m0, s61, 0
    s_nop 0
    buffer_load_dwordx4 v8, s[32:35], s45 offen lds
    s_add_u32 m0, s61, 1024
    s_nop 0
    buffer_load_dwordx4 v9, s[32:35], s45 offen lds
    s_add_u32 m0, s61, 2048
    s_nop 0
    buffer_load_dwordx4 v10, s[32:35], s45 offen lds
    s_add_u32 m0, s61, 3072
    s_nop 0
    buffer_load_dwordx4 v11, s[32:35], s45 offen lds
    s_add_u32 m0, s61, 4096
    s_nop 0
    buffer_load_dwordx4 v12, s[32:35], s45 offen lds
    s_add_u32 m0, s61, 5120
    s_nop 0
    buffer_load_dwordx4 v13, s[32:35], s45 offen lds
    s_add_u32 m0, s61, 6144
    s_nop 0
    buffer_load_dwordx4 v14, s[32:35], s45 offen lds
    s_add_u32 m0, s61, 7168
    s_nop 0
    buffer_load_dwordx4 v15, s[32:35], s45 offen lds
    s_add_u32 s45, s45, 128
    s_waitcnt vmcnt(22)
    s_barrier
    s_add_u32 m0, s62, 24640
    s_nop 0
    buffer_load_dwordx4 v16, s[36:39], s46 offen lds
    s_add_u32 m0, s62, 25664
    s_nop 0
    buffer_load_dwordx4 v17, s[36:39], s46 offen lds
    s_add_u32 m0, s62, 26688
    s_nop 0
    buffer_load_dwordx4 v18, s[36:39], s46 offen lds
    s_add_u32 s46, s46, 98304
    s_waitcnt vmcnt(14)
    s_barrier
    s_add_u32 m0, s62, 36960
    s_nop 0
    buffer_load_dwordx4 v16, s[36:39], s46 offen lds
    s_add_u32 m0, s62, 37984
    s_nop 0
    buffer_load_dwordx4 v17, s[36:39], s46 offen lds
    s_add_u32 m0, s62, 39008
    s_nop 0
    buffer_load_dwordx4 v18, s[36:39], s46 offen lds
    s_add_u32 s46, s46, 98304
    s_add_u32 m0, s61, 32768
    s_nop 0
    buffer_load_dwordx4 v8, s[32:35], s45 offen lds
    s_add_u32 m0, s61, 33792
    s_nop 0
    buffer_load_dwordx4 v9, s[32:35], s45 offen lds
    s_add_u32 m0, s61, 34816
    s_nop 0
    buffer_load_dwordx4 v10, s[32:35], s45 offen lds
    s_add_u32 m0, s61, 35840
    s_nop 0
    buffer_load_dwordx4 v11, s[32:35], s45 offen lds
    s_add_u32 m0, s61, 36864
    s_nop 0
    buffer_load_dwordx4 v12, s[32:35], s45 offen lds
    s_add_u32 m0, s61, 37888
    s_nop 0
    buffer_load_dwordx4 v13, s[32:35], s45 offen lds
    s_add_u32 m0, s61, 38912
    s_nop 0
    buffer_load_dwordx4 v14, s[32:35], s45 offen lds
    s_add_u32 m0, s61, 39936
    s_nop 0
    buffer_load_dwordx4 v15, s[32:35], s45 offen lds
    s_add_u32 s45, s45, 128
    s_waitcnt vmcnt(22)
    s_barrier
    s_add_u32 m0, s62, 49280
    s_nop 0
    buffer_load_dwordx4 v16, s[36:39], s46 offen lds
    s_add_u32 m0, s62, 50304
    s_nop 0
    buffer_load_dwordx4 v17, s[36:39], s46 offen lds
    s_add_u32 m0, s62, 51328
    s_nop 0
    buffer_load_dwordx4 v18, s[36:39], s46 offen lds
    s_add_u32 s46, s46, 98304
    s_waitcnt vmcnt(14)
    s_barrier
    s_add_u32 m0, s62, 0
    s_nop 0
    buffer_load_dwordx4 v16, s[36:39], s46 offen lds
    s_add_u32 m0, s62, 1024
    s_nop 0
    buffer_load_dwordx4 v17, s[36:39], s46 offen lds
    s_add_u32 m0, s62, 2048
    s_nop 0
    buffer_load_dwordx4 v18, s[36:39], s46 offen lds
    s_add_u32 s46, s46, 98304
    s_add_u32 m0, s61, 65536
    s_nop 0
    buffer_load_dwordx4 v8, s[32:35], s45 offen lds
    s_add_u32 m0, s61, 66560
    s_nop 0
    buffer_load_dwordx4 v9, s[32:35], s45 offen lds
    s_add_u32 m0, s61, 67584
    s_nop 0
    buffer_load_dwordx4 v10, s[32:35], s45 offen lds
    s_add_u32 m0, s61, 68608
    s_nop 0
    buffer_load_dwordx4 v11, s[32:35], s45 offen lds
    s_add_u32 m0, s61, 69632
    s_nop 0
    buffer_load_dwordx4 v12, s[32:35], s45 offen lds
    s_add_u32 m0, s61, 70656
    s_nop 0
    buffer_load_dwordx4 v13, s[32:35], s45 offen lds
    s_add_u32 m0, s61, 71680
    s_nop 0
    buffer_load_dwordx4 v14, s[32:35], s45 offen lds
    s_add_u32 m0, s61, 72704
    s_nop 0
    buffer_load_dwordx4 v15, s[32:35], s45 offen lds
    s_add_u32 s45, s45, 128
    s_waitcnt vmcnt(22)
    s_barrier
    s_add_u32 m0, s62, 12320
    s_nop 0
    buffer_load_dwordx4 v16, s[36:39], s46 offen lds
    s_add_u32 m0, s62, 13344
    s_nop 0
    buffer_load_dwordx4 v17, s[36:39], s46 offen lds
    s_add_u32 m0, s62, 14368
    s_nop 0
    buffer_load_dwordx4 v18, s[36:39], s46 offen lds
    s_add_u32 s46, s46, 98304
    s_waitcnt vmcnt(14)
    s_barrier
    s_add_u32 m0, s62, 24640
    s_nop 0
    buffer_load_dwordx4 v16, s[36:39], s46 offen lds
    s_add_u32 m0, s62, 25664
    s_nop 0
    buffer_load_dwordx4 v17, s[36:39], s46 offen lds
    s_add_u32 m0, s62, 26688
    s_nop 0
    buffer_load_dwordx4 v18, s[36:39], s46 offen lds
    s_add_u32 s46, s46, 98304
    s_add_u32 m0, s61, 0
    s_nop 0
    buffer_load_dwordx4 v8, s[32:35], s45 offen lds
    s_add_u32 m0, s61, 1024
    s_nop 0
    buffer_load_dwordx4 v9, s[32:35], s45 offen lds
    s_add_u32 m0, s61, 2048
    s_nop 0
    buffer_load_dwordx4 v10, s[32:35], s45 offen lds
    s_add_u32 m0, s61, 3072
    s_nop 0
    buffer_load_dwordx4 v11, s[32:35], s45 offen lds
    s_add_u32 m0, s61, 4096
    s_nop 0
    buffer_load_dwordx4 v12, s[32:35], s45 offen lds
    s_add_u32 m0, s61, 5120
    s_nop 0
    buffer_load_dwordx4 v13, s[32:35], s45 offen lds
    s_add_u32 m0, s61, 6144
    s_nop 0
    buffer_load_dwordx4 v14, s[32:35], s45 offen lds
    s_add_u32 m0, s61, 7168
    s_nop 0
    buffer_load_dwordx4 v15, s[32:35], s45 offen lds
    s_add_u32 s45, s45, 128
    s_waitcnt vmcnt(22)
    s_barrier
    s_add_u32 m0, s62, 36960
    s_nop 0
    buffer_load_dwordx4 v16, s[36:39], s46 offen lds
    s_add_u32 m0, s62, 37984
    s_nop 0
    buffer_load_dwordx4 v17, s[36:39], s46 offen lds
    s_add_u32 m0, s62, 39008
    s_nop 0
    buffer_load_dwordx4 v18, s[36:39], s46 offen lds
    s_add_u32 s46, s46, 98304
    s_waitcnt vmcnt(14)
    s_barrier
    s_add_u32 m0, s62, 49280
    s_nop 0
    buffer_load_dwordx4 v16, s[36:39], s46 offen lds
    s_add_u32 m0, s62, 50304
    s_nop 0
    buffer_load_dwordx4 v17, s[36:39], s46 offen lds
    s_add_u32 m0, s62, 51328
    s_nop 0
    buffer_load_dwordx4 v18, s[36:39], s46 offen lds
    s_add_u32 s46, s46, 98304
    s_load_dwordx2 s[92:93], s[0:1], 72
    s_waitcnt lgkmcnt(0)
    s_mov_b32 s88, s92
    s_and_b32 s89, s93, 0xffff
    s_mov_b32 s90, 256
    s_mov_b32 s91, 0x20000
    v_mov_b32 v131, 240
    buffer_load_dword v130, v131, s[88:91], 0 offen sc1
    s_waitcnt vmcnt(15)
    s_barrier
    s_waitcnt vmcnt(4)
    s_barrier
    s_waitcnt vmcnt(1)
    s_barrier
    s_barrier
    s_branch gated_mix__mha_block__glu_gated_geglu__prompt_kernel_f6ldone
gated_mix__mha_block__glu_gated_geglu__prompt_kernel_idlel:
    s_waitcnt lgkmcnt(0)
    s_cmp_eq_u32 s2, 224
    s_cbranch_scc0 gated_mix__mha_block__glu_gated_geglu__prompt_kernel_notag
    s_cmp_eq_u32 s22, 0
    s_cbranch_scc0 gated_mix__mha_block__glu_gated_geglu__prompt_kernel_notag
    s_load_dwordx2 s[72:73], s[0:1], 72
    s_waitcnt lgkmcnt(0)
    s_mov_b32 s68, s72
    s_and_b32 s69, s73, 0xffff
    s_mov_b32 s70, 256
    s_mov_b32 s71, 0x20000
    s_memrealtime s[74:75]
    s_waitcnt lgkmcnt(0)
    s_or_b32 s74, s74, 1
    s_mov_b64 exec, 1
    v_mov_b32 v4, s74
    v_mov_b32 v3, 240
    buffer_store_dword v4, v3, s[68:71], 0 offen sc1
    s_mov_b64 exec, -1
gated_mix__mha_block__glu_gated_geglu__prompt_kernel_notag:
    v_lshlrev_b32 v21, 4, v2
    s_mov_b32 s68, s4
    s_and_b32 s69, s5, 0xffff
    s_mov_b32 s70, 2621440
    s_mov_b32 s71, 0x20000
    s_mov_b32 s72, s6
    s_and_b32 s73, s7, 0xffff
    s_mov_b32 s74, 2457600
    s_mov_b32 s75, 0x20000
    s_mov_b32 s76, s12
    s_and_b32 s77, s13, 0xffff
    s_mov_b32 s78, 1966080
    s_mov_b32 s79, 0x20000
    s_mov_b32 s80, s14
    s_and_b32 s81, s15, 0xffff
    s_mov_b32 s82, 1966080
    s_mov_b32 s83, 0x20000
    s_sub_u32 s24, s2, 96
    s_lshl_b32 s24, s24, 2
    s_add_u32 s24, s24, s22
    s_lshl_b32 s24, s24, 10
    v_add_u32 v21, s24, v21
    v_add_u32 v22, 655360, v21
    v_add_u32 v23, 1310720, v21
    v_add_u32 v24, 1966080, v21
    buffer_load_dwordx4 v[60:63], v21, s[72:75], 0 offen
    buffer_load_dwordx4 v[60:63], v21, s[76:79], 0 offen
    buffer_load_dwordx4 v[60:63], v21, s[80:83], 0 offen
    buffer_load_dwordx4 v[60:63], v21, s[68:71], 0 offen
    buffer_load_dwordx4 v[60:63], v22, s[68:71], 0 offen
    buffer_load_dwordx4 v[60:63], v22, s[72:75], 0 offen
    buffer_load_dwordx4 v[60:63], v22, s[76:79], 0 offen
    buffer_load_dwordx4 v[60:63], v22, s[80:83], 0 offen
    buffer_load_dwordx4 v[60:63], v23, s[68:71], 0 offen
    buffer_load_dwordx4 v[60:63], v24, s[68:71], 0 offen
    buffer_load_dwordx4 v[60:63], v23, s[72:75], 0 offen
    buffer_load_dwordx4 v[60:63], v23, s[76:79], 0 offen
    buffer_load_dwordx4 v[60:63], v23, s[80:83], 0 offen
    buffer_load_dwordx4 v[60:63], v24, s[72:75], 0 offen
    s_add_u32 s22, s22, 4
gated_mix__mha_block__glu_gated_geglu__prompt_kernel_idlec:
    s_waitcnt lgkmcnt(0)
    s_mov_b32 s32, s4
    s_and_b32 s33, s5, 0xffff
    s_mov_b32 s34, 2621440
    s_mov_b32 s35, 0x20000
    s_mov_b32 s40, s48
    s_and_b32 s41, s49, 0xffff
    s_mov_b32 s42, 26214400
    s_mov_b32 s43, 0x20000
    s_lshr_b32 s23, s2, 3
    s_sub_u32 s23, s23, 28
    s_lshl_b32 s23, s23, 3
    s_and_b32 s24, s2, 7
    s_add_u32 s23, s23, s24
    s_lshl_b32 s23, s23, 3
    s_add_u32 s65, s23, s22
    s_mov_b32 s66, 0
gated_mix__mha_block__glu_gated_geglu__prompt_kernel_idleloop:
    s_lshl_b32 s64, s65, 2
    s_add_u32 s64, s64, s66
    s_mov_b32 s68, s16
    s_and_b32 s69, s17, 0xffff
    s_mov_b32 s70, 1966080
    s_mov_b32 s71, 0x20000
    s_mov_b32 s76, s8
    s_and_b32 s77, s9, 0xffff
    s_mov_b32 s78, 819200
    s_mov_b32 s79, 0x20000
    s_mov_b32 s80, s18
    s_and_b32 s81, s19, 0xffff
    s_mov_b32 s82, 1280
    s_mov_b32 s83, 0x20000
    v_lshrrev_b32 v3, 2, v2
    v_mul_u32_u24 v3, 1280, v3
    v_and_b32 v4, 3, v2
    v_lshl_add_u32 v100, v4, 4, v3
    v_bfe_u32 v5, v2, 4, 1
    v_lshrrev_b32 v6, 5, v2
    v_lshl_add_u32 v5, v5, 1, v6
    v_mul_u32_u24 v5, 20, v5
    v_bfe_u32 v6, v2, 2, 2
    v_add3_u32 v5, v5, v6, 16
    v_mul_u32_u24 v5, 1280, v5
    v_lshl_add_u32 v101, v4, 4, v5
    s_add_u32 s56, s64, 0
    s_cmp_ge_u32 s56, 1920
    s_cbranch_scc1 gated_mix__mha_block__glu_gated_geglu__prompt_kernel_pl_o0_id
    s_mul_i32 s23, s56, 683
    s_lshr_b32 s23, s23, 16
    s_mul_i32 s24, s23, 96
    s_sub_u32 s24, s56, s24
    s_mul_i32 s24, s24, 20480
    s_lshl_b32 s23, s23, 6
    s_add_u32 s23, s23, s24
    buffer_load_dwordx4 v[64:67], v100, s[68:71], s23 offen
    s_branch gated_mix__mha_block__glu_gated_geglu__prompt_kernel_pl_n0_id
gated_mix__mha_block__glu_gated_geglu__prompt_kernel_pl_o0_id:
    s_sub_u32 s25, s56, 1920
    s_mul_i32 s23, s25, 1639
    s_lshr_b32 s23, s23, 16
    s_mul_i32 s24, s23, 40
    s_sub_u32 s24, s25, s24
    s_lshl_b32 s23, s23, 6
    s_cmp_ge_u32 s24, 32
    s_cbranch_scc1 gated_mix__mha_block__glu_gated_geglu__prompt_kernel_pl_t0_id
    s_mul_i32 s24, s24, 25600
    s_add_u32 s23, s23, s24
    buffer_load_dwordx4 v[64:67], v100, s[76:79], s23 offen
    s_branch gated_mix__mha_block__glu_gated_geglu__prompt_kernel_pl_n0_id
gated_mix__mha_block__glu_gated_geglu__prompt_kernel_pl_t0_id:
    s_sub_u32 s24, s24, 32
    s_mul_i32 s24, s24, 102400
    s_add_u32 s23, s23, s24
    buffer_load_dwordx4 v[64:67], v101, s[76:79], s23 offen
gated_mix__mha_block__glu_gated_geglu__prompt_kernel_pl_n0_id:
    s_add_u32 s57, s64, 1024
    s_cmp_ge_u32 s57, 1920
    s_cbranch_scc1 gated_mix__mha_block__glu_gated_geglu__prompt_kernel_pl_o1_id
    s_mul_i32 s23, s57, 683
    s_lshr_b32 s23, s23, 16
    s_mul_i32 s24, s23, 96
    s_sub_u32 s24, s57, s24
    s_mul_i32 s24, s24, 20480
    s_lshl_b32 s23, s23, 6
    s_add_u32 s23, s23, s24
    buffer_load_dwordx4 v[68:71], v100, s[68:71], s23 offen
    s_branch gated_mix__mha_block__glu_gated_geglu__prompt_kernel_pl_n1_id
gated_mix__mha_block__glu_gated_geglu__prompt_kernel_pl_o1_id:
    s_sub_u32 s25, s57, 1920
    s_mul_i32 s23, s25, 1639
    s_lshr_b32 s23, s23, 16
    s_mul_i32 s24, s23, 40
    s_sub_u32 s24, s25, s24
    s_lshl_b32 s23, s23, 6
    s_cmp_ge_u32 s24, 32
    s_cbranch_scc1 gated_mix__mha_block__glu_gated_geglu__prompt_kernel_pl_t1_id
    s_mul_i32 s24, s24, 25600
    s_add_u32 s23, s23, s24
    buffer_load_dwordx4 v[68:71], v100, s[76:79], s23 offen
    s_branch gated_mix__mha_block__glu_gated_geglu__prompt_kernel_pl_n1_id
gated_mix__mha_block__glu_gated_geglu__prompt_kernel_pl_t1_id:
    s_sub_u32 s24, s24, 32
    s_mul_i32 s24, s24, 102400
    s_add_u32 s23, s23, s24
    buffer_load_dwordx4 v[68:71], v101, s[76:79], s23 offen
gated_mix__mha_block__glu_gated_geglu__prompt_kernel_pl_n1_id:
    s_add_u32 s58, s64, 2048
    s_cmp_ge_u32 s58, 1920
    s_cbranch_scc1 gated_mix__mha_block__glu_gated_geglu__prompt_kernel_pl_o2_id
    s_mul_i32 s23, s58, 683
    s_lshr_b32 s23, s23, 16
    s_mul_i32 s24, s23, 96
    s_sub_u32 s24, s58, s24
    s_mul_i32 s24, s24, 20480
    s_lshl_b32 s23, s23, 6
    s_add_u32 s23, s23, s24
    buffer_load_dwordx4 v[72:75], v100, s[68:71], s23 offen
    s_branch gated_mix__mha_block__glu_gated_geglu__prompt_kernel_pl_n2_id
gated_mix__mha_block__glu_gated_geglu__prompt_kernel_pl_o2_id:
    s_sub_u32 s25, s58, 1920
    s_mul_i32 s23, s25, 1639
    s_lshr_b32 s23, s23, 16
    s_mul_i32 s24, s23, 40
    s_sub_u32 s24, s25, s24
    s_lshl_b32 s23, s23, 6
    s_cmp_ge_u32 s24, 32
    s_cbranch_scc1 gated_mix__mha_block__glu_gated_geglu__prompt_kernel_pl_t2_id
    s_mul_i32 s24, s24, 25600
    s_add_u32 s23, s23, s24
    buffer_load_dwordx4 v[72:75], v100, s[76:79], s23 offen
    s_branch gated_mix__mha_block__glu_gated_geglu__prompt_kernel_pl_n2_id
gated_mix__mha_block__glu_gated_geglu__prompt_kernel_pl_t2_id:
    s_sub_u32 s24, s24, 32
    s_mul_i32 s24, s24, 102400
    s_add_u32 s23, s23, s24
    buffer_load_dwordx4 v[72:75], v101, s[76:79], s23 offen
gated_mix__mha_block__glu_gated_geglu__prompt_kernel_pl_n2_id:
    v_and_b32 v3, 31, v2
    v_lshlrev_b32 v3, 4, v3
    v_lshrrev_b32 v102, 5, v2
    s_lshl_b32 s23, s64, 1
    v_add_u32 v102, s23, v102
    v_mul_u32_u24 v5, 1280, v102
    v_add_u32 v5, v5, v3
    v_and_b32 v6, 16, v2
    v_cmp_ne_u32 vcc, 0, v6
    v_mov_b32 v7, 0x7ff00000
    v_add_u32 v6, 1024, v5
    v_add_u32 v4, 1024, v3
    v_cndmask_b32 v6, v6, v7, vcc
    v_cndmask_b32 v4, v4, v7, vcc
    buffer_load_dwordx4 v[76:79], v5, s[32:35], 0 offen
    buffer_load_dwordx4 v[80:83], v5, s[32:35], 0 offen offset:512
    buffer_load_dwordx4 v[84:87], v6, s[32:35], 0 offen
    buffer_load_dwordx4 v[88:91], v3, s[80:83], 0 offen
    buffer_load_dwordx4 v[92:95], v3, s[80:83], 0 offen offset:512
    buffer_load_dwordx4 v[96:99], v4, s[80:83], 0 offen
    s_waitcnt vmcnt(0)
    v_mov_b32 v3, 0
    v_dot2c_f32_bf16 v3, v76, v88
    v_dot2c_f32_bf16 v3, v77, v89
    v_dot2c_f32_bf16 v3, v78, v90
    v_dot2c_f32_bf16 v3, v79, v91
    v_dot2c_f32_bf16 v3, v80, v92
    v_dot2c_f32_bf16 v3, v81, v93
    v_dot2c_f32_bf16 v3, v82, v94
    v_dot2c_f32_bf16 v3, v83, v95
    v_dot2c_f32_bf16 v3, v84, v96
    v_dot2c_f32_bf16 v3, v85, v97
    v_dot2c_f32_bf16 v3, v86, v98
    v_dot2c_f32_bf16 v3, v87, v99
    s_nop 3
    v_add_f32_dpp v3, v3, v3 row_shr:1 row_mask:0xf bank_mask:0xf bound_ctrl:0
    s_nop 1
    v_add_f32_dpp v3, v3, v3 row_shr:2 row_mask:0xf bank_mask:0xf bound_ctrl:0
    s_nop 1
    v_add_f32_dpp v3, v3, v3 row_shr:4 row_mask:0xf bank_mask:0xf bound_ctrl:0
    s_nop 1
    v_add_f32_dpp v3, v3, v3 row_shr:8 row_mask:0xf bank_mask:0xf bound_ctrl:0
    s_nop 1
    v_add_f32_dpp v3, v3, v3 row_bcast:15 row_mask:0xa bank_mask:0xf
    s_nop 1
    v_mul_f32 v3, 0xbfb8aa3b, v3
    v_exp_f32 v3, v3
    s_nop 0
    v_add_f32 v3, 1.0, v3
    v_rcp_f32 v3, v3
    v_lshlrev_b32 v102, 2, v102
    v_and_b32 v6, 31, v2
    v_cmp_eq_u32 vcc, 31, v6
    s_mov_b32 s23, 24117248
    s_and_saveexec_b64 s[50:51], vcc
    s_cbranch_execz gated_mix__mha_block__glu_gated_geglu__prompt_kernel_gate_done_id
    buffer_store_dword v3, v102, s[40:43], s23 offen sc1
gated_mix__mha_block__glu_gated_geglu__prompt_kernel_gate_done_id:
    s_mov_b64 exec, s[50:51]
    s_lshl_b32 s23, s22, 9
    s_add_u32 s23, s23, 0
    v_and_b32 v4, 31, v2
    v_lshlrev_b32 v4, 4, v4
    v_add_u32 v4, s23, v4
    v_lshrrev_b32 v7, 5, v2
    v_bfe_u32 v5, v2, 2, 2
    v_lshl_add_u32 v5, v7, 2, v5
    v_lshlrev_b32 v5, 6, v5
    v_bfe_u32 v6, v2, 4, 1
    v_lshl_add_u32 v5, v6, 5, v5
    v_and_b32 v6, 3, v2
    v_lshl_add_u32 v5, v6, 3, v5
    v_add_u32 v5, s23, v5
    v_lshlrev_b32 v7, 4, v2
    s_mov_b32 exec_hi, 0
    ds_write_b128 v4, v[64:67]
    s_mov_b64 exec, -1
    s_waitcnt lgkmcnt(0)
    ds_read_b64_tr_b16 v[104:105], v5
    s_waitcnt lgkmcnt(0)
    s_mov_b32 exec_lo, 0
    ds_write_b128 v4, v[64:67]
    s_mov_b64 exec, -1
    s_waitcnt lgkmcnt(0)
    ds_read_b64_tr_b16 v[106:107], v5
    s_waitcnt lgkmcnt(0)
    s_lshl_b32 s23, s56, 10
    s_add_u32 s23, s23, 15728640
    buffer_store_dwordx4 v[104:107], v7, s[40:43], s23 offen sc1
    s_mov_b32 exec_hi, 0
    ds_write_b128 v4, v[68:71]
    s_mov_b64 exec, -1
    s_waitcnt lgkmcnt(0)
    ds_read_b64_tr_b16 v[108:109], v5
    s_waitcnt lgkmcnt(0)
    s_mov_b32 exec_lo, 0
    ds_write_b128 v4, v[68:71]
    s_mov_b64 exec, -1
    s_waitcnt lgkmcnt(0)
    ds_read_b64_tr_b16 v[110:111], v5
    s_waitcnt lgkmcnt(0)
    s_lshl_b32 s23, s57, 10
    s_add_u32 s23, s23, 15728640
    buffer_store_dwordx4 v[108:111], v7, s[40:43], s23 offen sc1
    s_cmp_ge_u32 s58, 2720
    s_cbranch_scc1 gated_mix__mha_block__glu_gated_geglu__prompt_kernel_prep_done_id
    s_mov_b32 exec_hi, 0
    ds_write_b128 v4, v[72:75]
    s_mov_b64 exec, -1
    s_waitcnt lgkmcnt(0)
    ds_read_b64_tr_b16 v[112:113], v5
    s_waitcnt lgkmcnt(0)
    s_mov_b32 exec_lo, 0
    ds_write_b128 v4, v[72:75]
    s_mov_b64 exec, -1
    s_waitcnt lgkmcnt(0)
    ds_read_b64_tr_b16 v[114:115], v5
    s_waitcnt lgkmcnt(0)
    s_lshl_b32 s23, s58, 10
    s_add_u32 s23, s23, 15728640
    buffer_store_dwordx4 v[112:115], v7, s[40:43], s23 offen sc1
gated_mix__mha_block__glu_gated_geglu__prompt_kernel_prep_done_id:
    v_mov_b32 v120, -1
    v_mov_b32 v121, -1
    v_mov_b32 v122, -1
    v_mov_b32 v123, -1
    v_lshlrev_b32 v3, 4, v2
    s_mul_i32 s23, s64, 2560
    s_add_u32 s23, s23, 18874368
    buffer_store_dwordx4 v[120:123], v3, s[40:43], s23 offen sc1
    buffer_store_dwordx4 v[120:123], v3, s[40:43], s23 offen offset:1024 sc1
    s_mov_b32 exec_hi, 0
    buffer_store_dwordx4 v[120:123], v3, s[40:43], s23 offen offset:2048 sc1
    s_mov_b64 exec, -1
    s_add_u32 s66, s66, 1
    s_cmp_lt_u32 s66, 4
    s_cbranch_scc1 gated_mix__mha_block__glu_gated_geglu__prompt_kernel_idleloop
    s_load_dwordx2 s[92:93], s[0:1], 72
    s_waitcnt lgkmcnt(0)
    s_mov_b32 s88, s92
    s_and_b32 s89, s93, 0xffff
    s_mov_b32 s90, 256
    s_mov_b32 s91, 0x20000
    v_mov_b32 v131, 240
    buffer_load_dword v130, v131, s[88:91], 0 offen sc1
    s_branch gated_mix__mha_block__glu_gated_geglu__prompt_kernel_fin
gated_mix__mha_block__glu_gated_geglu__prompt_kernel_f6ldone:
    s_barrier
    s_branch gated_mix__mha_block__glu_gated_geglu__prompt_kernel_f6fin
gated_mix__mha_block__glu_gated_geglu__prompt_kernel_fin:
    s_mov_b64 exec, -1
    s_waitcnt vmcnt(0) lgkmcnt(0)
    s_barrier
    s_lshl_b32 s70, s29, 3
    s_add_u32 s70, s70, s20
    s_lshr_b32 s23, s2, 3
    s_sub_u32 s23, s23, 28
    s_lshl_b32 s23, s23, 3
    s_and_b32 s24, s2, 7
    s_add_u32 s23, s23, s24
    s_add_u32 s23, s23, 64
    s_cmp_eq_u32 s29, 4
    s_cselect_b32 s70, s23, s70
    s_mov_b32 s71, -1
    v_readfirstlane_b32 s83, v0
    v_readfirstlane_b32 s61, v130
    s_nop 3
    s_lshr_b32 s83, s83, 6
    s_cmp_eq_u32 s83, 4
    s_cbranch_scc0 gated_mix__mha_block__glu_gated_geglu__prompt_kernel_p2_entry
    s_cmp_eq_u32 s61, 0
    s_cbranch_scc1 gated_mix__mha_block__glu_gated_geglu__prompt_kernel_p2_entry
    v_mov_b32 v14, s61
    s_cmp_ge_u32 s70, 64
    s_cbranch_scc1 gated_mix__mha_block__glu_gated_geglu__prompt_kernel_mk_side
    s_and_b32 s60, s2, 6
    v_lshrrev_b32 v13, 1, v2
    v_lshlrev_b32 v13, 3, v13
    v_and_b32 v15, 1, v2
    v_add3_u32 v13, v13, v15, s60
    v_lshlrev_b32 v13, 9, v13
    s_lshl_b32 s60, s70, 2
    s_add_u32 s60, s60, 24182784
    buffer_store_dword v14, v13, s[40:43], s60 offen sc1
    s_mov_b32 s70, -1
    s_branch gated_mix__mha_block__glu_gated_geglu__prompt_kernel_p2_entry
gated_mix__mha_block__glu_gated_geglu__prompt_kernel_mk_side:
    s_lshl_b32 s60, s70, 2
    s_add_u32 s60, s60, 24182784
    v_lshlrev_b32 v13, 9, v2
    buffer_store_dword v14, v13, s[40:43], s60 offen sc1
    s_add_u32 s60, s60, 32768
    buffer_store_dword v14, v13, s[40:43], s60 offen sc1
    s_add_u32 s60, s60, 32768
    buffer_store_dword v14, v13, s[40:43], s60 offen sc1
    s_add_u32 s60, s60, 32768
    buffer_store_dword v14, v13, s[40:43], s60 offen sc1
    s_mov_b32 s70, -1
    s_branch gated_mix__mha_block__glu_gated_geglu__prompt_kernel_p2_entry
gated_mix__mha_block__glu_gated_geglu__prompt_kernel_f6fin:
    s_mov_b64 exec, -1
    s_mov_b32 s70, -1
    s_lshl_b32 s71, s20, 8
    s_add_u32 s71, s71, s21
gated_mix__mha_block__glu_gated_geglu__prompt_kernel_p2_entry:
    s_load_dwordx2 s[4:5], s[0:1], 80
    s_load_dwordx2 s[38:39], s[0:1], 72
    s_load_dwordx2 s[48:49], s[0:1], 64
    v_lshrrev_b32 v1, 6, v0
    v_and_b32 v2, 63, v0
    v_readfirstlane_b32 s12, v1
    s_and_b32 s13, s2, 7
    s_lshr_b32 s14, s2, 3
    s_and_b32 s15, s14, 3
    s_lshl_b32 s16, s13, 2
    s_add_u32 s16, s16, s15
    s_and_b32 s21, s12, 3
    s_lshr_b32 s22, s12, 2
    s_lshr_b32 s17, s14, 2
    s_lshl_b32 s17, s17, 3
    s_lshl_b32 s15, s21, 1
    s_add_u32 s17, s17, s15
    s_lshl_b32 s23, s13, 3
    s_and_b32 s15, s14, 7
    s_add_u32 s23, s23, s15
    s_lshr_b32 s24, s14, 3
    s_waitcnt lgkmcnt(0)
    s_mov_b32 s8, s4
    s_and_b32 s9, s5, 0xffff
    s_mov_b32 s10, 26214400
    s_mov_b32 s11, 0x20000
    v_lshlrev_b32 v4, 4, v2
    s_mul_i32 s13, s22, 53248
    v_add_u32 v5, s13, v4
    v_and_b32 v3, 31, v2
    v_lshlrev_b32 v9, 3, v3
    v_add_u32 v9, 1024, v9
    v_add_u32 v6, s13, v9
    v_add_u32 v10, 13312, v5
    v_add_u32 v11, 13312, v6
    s_mov_b32 s40, 26624
    s_mov_b32 s41, 39936
    s_mov_b32 s42, 3
    v_mov_b32 v7, v4
    v_mov_b32 v8, v4
    s_mul_i32 s19, s21, 3072
    s_add_u32 s19, s19, s13
    s_mul_i32 s18, s16, 212992
    s_mul_i32 s14, s22, 106496
    s_add_u32 s18, s18, s14
    s_mul_i32 s14, s21, 3072
    s_add_u32 s18, s18, s14
    s_add_u32 s18, s18, 2621440
    s_mov_b32 s52, 0x30800000
    s_mov_b32 s53, 0x58800000
    s_cmp_lt_u32 s12, 4
    s_cbranch_scc1 gated_mix__mha_block__glu_gated_geglu__prompt_kernel_p2_gwait
    v_mov_b32 v12, 162176
    s_cmp_eq_u32 s12, 4
    s_cbranch_scc0 gated_mix__mha_block__glu_gated_geglu__prompt_kernel_sy_spin
    s_mov_b32 s56, s38
    s_and_b32 s57, s39, 0xffff
    s_mov_b32 s58, 256
    s_mov_b32 s59, 0x20000
    s_waitcnt vmcnt(0)
    v_readfirstlane_b32 s61, v130
    s_mov_b32 s60, 0
gated_mix__mha_block__glu_gated_geglu__prompt_kernel_tg_loop:
    s_cmp_lg_u32 s61, 0
    s_cbranch_scc1 gated_mix__mha_block__glu_gated_geglu__prompt_kernel_tg_ok
    v_mov_b32 v131, 240
    buffer_load_dword v130, v131, s[56:59], 0 offen sc1
    s_waitcnt vmcnt(0)
    v_readfirstlane_b32 s61, v130
    s_add_u32 s60, s60, 1
    s_cmp_lt_u32 s60, 0x40000
    s_cbranch_scc1 gated_mix__mha_block__glu_gated_geglu__prompt_kernel_tg_loop
gated_mix__mha_block__glu_gated_geglu__prompt_kernel_tg_ok:
    v_mov_b32 v14, s61
    s_mov_b64 exec, 1
    ds_write_b32 v12, v14 offset:4
    s_mov_b64 exec, -1
    s_cmp_eq_u32 s70, -1
    s_cbranch_scc1 gated_mix__mha_block__glu_gated_geglu__prompt_kernel_sy_noarr
    s_cmp_ge_u32 s70, 64
    s_cbranch_scc1 gated_mix__mha_block__glu_gated_geglu__prompt_kernel_sy_side
    s_and_b32 s60, s2, 6
    v_lshrrev_b32 v13, 1, v2
    v_lshlrev_b32 v13, 3, v13
    v_and_b32 v15, 1, v2
    v_add3_u32 v13, v13, v15, s60
    v_lshlrev_b32 v13, 9, v13
    s_lshl_b32 s60, s70, 2
    s_add_u32 s60, s60, 24182784
    buffer_store_dword v14, v13, s[8:11], s60 offen sc1
    s_branch gated_mix__mha_block__glu_gated_geglu__prompt_kernel_sy_noarr
gated_mix__mha_block__glu_gated_geglu__prompt_kernel_sy_side:
    s_lshl_b32 s60, s70, 2
    s_add_u32 s60, s60, 24182784
    v_lshlrev_b32 v13, 9, v2
    buffer_store_dword v14, v13, s[8:11], s60 offen sc1
    s_add_u32 s60, s60, 32768
    buffer_store_dword v14, v13, s[8:11], s60 offen sc1
    s_add_u32 s60, s60, 32768
    buffer_store_dword v14, v13, s[8:11], s60 offen sc1
    s_add_u32 s60, s60, 32768
    buffer_store_dword v14, v13, s[8:11], s60 offen sc1
gated_mix__mha_block__glu_gated_geglu__prompt_kernel_sy_noarr:
    s_mov_b64 exec, 0xffffff
    v_lshlrev_b32 v13, 2, v2
    s_lshl_b32 s60, s2, 9
    s_add_u32 s60, s60, 24182784
    v_add_u32 v13, s60, v13
    s_mov_b32 s60, 0
gated_mix__mha_block__glu_gated_geglu__prompt_kernel_sy_poll:
    buffer_load_dword v15, v13, s[8:11], 0 offen sc1
    s_waitcnt vmcnt(0)
    v_cmp_ne_u32 vcc, v15, v14
    s_add_u32 s60, s60, 1
    s_nop 1
    s_cbranch_vccz gated_mix__mha_block__glu_gated_geglu__prompt_kernel_sy_done
    s_sleep 8
    s_cmp_lt_u32 s60, 0x40000
    s_cbranch_scc1 gated_mix__mha_block__glu_gated_geglu__prompt_kernel_sy_poll
gated_mix__mha_block__glu_gated_geglu__prompt_kernel_sy_done:
    s_mov_b64 exec, 1
    v_mov_b32 v15, 1
    ds_write_b32 v12, v15
    s_mov_b64 exec, -1
    s_waitcnt lgkmcnt(0)
    s_branch gated_mix__mha_block__glu_gated_geglu__prompt_kernel_sy_go
gated_mix__mha_block__glu_gated_geglu__prompt_kernel_sy_spin:
    s_mov_b32 s60, 0
gated_mix__mha_block__glu_gated_geglu__prompt_kernel_sy_spin2:
    ds_read_b32 v15, v12
    s_waitcnt lgkmcnt(0)
    v_readfirstlane_b32 s56, v15
    s_add_u32 s60, s60, 1
    s_cmp_eq_u32 s56, 1
    s_cbranch_scc1 gated_mix__mha_block__glu_gated_geglu__prompt_kernel_sy_go
    s_sleep 2
    s_cmp_lt_u32 s60, 0x1000000
    s_cbranch_scc1 gated_mix__mha_block__glu_gated_geglu__prompt_kernel_sy_spin2
gated_mix__mha_block__glu_gated_geglu__prompt_kernel_sy_go:
    s_mul_i32 s13, s16, 81920
    s_mul_i32 s14, s17, 1280
    s_add_u32 s13, s13, s14
    s_mul_i32 s14, s21, 3072
    s_add_u32 m0, s14, 106496
    s_nop 0
    buffer_load_dwordx4 v4, s[8:11], s13 offen offset:0 lds
    buffer_load_dwordx4 v4, s[8:11], s13 offen offset:1024 lds
    buffer_load_dwordx4 v4, s[8:11], s13 offen offset:2048 lds
    s_mul_i32 s13, s16, 212992
    s_add_u32 s13, s13, s14
    s_add_u32 s13, s13, 2621440
    s_add_u32 s15, s13, 0
    s_add_u32 m0, s14, 0
    s_nop 0
    buffer_load_dwordx4 v4, s[8:11], s15 offen offset:0 lds
    buffer_load_dwordx4 v4, s[8:11], s15 offen offset:1024 lds
    buffer_load_dwordx4 v4, s[8:11], s15 offen offset:2048 lds
    s_cmp_eq_u32 s21, 3
    s_cbranch_scc0 gated_mix__mha_block__glu_gated_geglu__prompt_kernel_p2_ndp_1
    buffer_load_dwordx4 v4, s[8:11], s15 offen offset:3072 lds
gated_mix__mha_block__glu_gated_geglu__prompt_kernel_p2_ndp_1:
    s_add_u32 s15, s13, 106496
    s_add_u32 m0, s14, 53248
    s_nop 0
    buffer_load_dwordx4 v4, s[8:11], s15 offen offset:0 lds
    buffer_load_dwordx4 v4, s[8:11], s15 offen offset:1024 lds
    buffer_load_dwordx4 v4, s[8:11], s15 offen offset:2048 lds
    s_cmp_eq_u32 s21, 3
    s_cbranch_scc0 gated_mix__mha_block__glu_gated_geglu__prompt_kernel_p2_ndp_2
    buffer_load_dwordx4 v4, s[8:11], s15 offen offset:3072 lds
gated_mix__mha_block__glu_gated_geglu__prompt_kernel_p2_ndp_2:
    s_add_u32 s15, s13, 13312
    s_add_u32 m0, s14, 13312
    s_nop 0
    buffer_load_dwordx4 v4, s[8:11], s15 offen offset:0 lds
    buffer_load_dwordx4 v4, s[8:11], s15 offen offset:1024 lds
    buffer_load_dwordx4 v4, s[8:11], s15 offen offset:2048 lds
    s_cmp_eq_u32 s21, 3
    s_cbranch_scc0 gated_mix__mha_block__glu_gated_geglu__prompt_kernel_p2_ndp_3
    buffer_load_dwordx4 v4, s[8:11], s15 offen offset:3072 lds
gated_mix__mha_block__glu_gated_geglu__prompt_kernel_p2_ndp_3:
    s_add_u32 s15, s13, 119808
    s_add_u32 m0, s14, 66560
    s_nop 0
    buffer_load_dwordx4 v4, s[8:11], s15 offen offset:0 lds
    buffer_load_dwordx4 v4, s[8:11], s15 offen offset:1024 lds
    buffer_load_dwordx4 v4, s[8:11], s15 offen offset:2048 lds
    s_cmp_eq_u32 s21, 3
    s_cbranch_scc0 gated_mix__mha_block__glu_gated_geglu__prompt_kernel_p2_ndp_4
    buffer_load_dwordx4 v4, s[8:11], s15 offen offset:3072 lds
gated_mix__mha_block__glu_gated_geglu__prompt_kernel_p2_ndp_4:
    s_add_u32 s15, s13, 26624
    s_add_u32 m0, s14, 26624
    s_nop 0
    buffer_load_dwordx4 v4, s[8:11], s15 offen offset:0 lds
    buffer_load_dwordx4 v4, s[8:11], s15 offen offset:1024 lds
    buffer_load_dwordx4 v4, s[8:11], s15 offen offset:2048 lds
    s_cmp_eq_u32 s21, 3
    s_cbranch_scc0 gated_mix__mha_block__glu_gated_geglu__prompt_kernel_p2_ndp_5
    buffer_load_dwordx4 v4, s[8:11], s15 offen offset:3072 lds
gated_mix__mha_block__glu_gated_geglu__prompt_kernel_p2_ndp_5:
    s_add_u32 s15, s13, 133120
    s_add_u32 m0, s14, 79872
    s_nop 0
    buffer_load_dwordx4 v4, s[8:11], s15 offen offset:0 lds
    buffer_load_dwordx4 v4, s[8:11], s15 offen offset:1024 lds
    buffer_load_dwordx4 v4, s[8:11], s15 offen offset:2048 lds
    s_cmp_eq_u32 s21, 3
    s_cbranch_scc0 gated_mix__mha_block__glu_gated_geglu__prompt_kernel_p2_ndp_6
    buffer_load_dwordx4 v4, s[8:11], s15 offen offset:3072 lds
gated_mix__mha_block__glu_gated_geglu__prompt_kernel_p2_ndp_6:
    s_waitcnt vmcnt(12)
gated_mix__mha_block__glu_gated_geglu__prompt_kernel_p2_gwait:
    s_add_u32 s18, s18, 39936
    s_mul_i32 s13, s12, 12288
    s_mul_i32 s14, s24, 491520
    s_add_u32 s14, s14, s13
    s_add_u32 s26, s14, 15728640
    s_add_u32 s27, s26, 98304
    s_add_u32 s28, s27, 98304
    s_add_u32 s29, s28, 98304
    s_add_u32 s30, s29, 98304
    s_mul_i32 s14, s23, 98304
    s_add_u32 s14, s14, s13
    s_add_u32 s31, s14, 9437184
    s_mul_i32 s13, s12, 5120
    s_mul_i32 s14, s24, 204800
    s_add_u32 s14, s14, s13
    s_add_u32 s32, s14, 17694720
    s_add_u32 s33, s32, 40960
    s_add_u32 s34, s33, 40960
    s_add_u32 s35, s34, 40960
    s_add_u32 s36, s35, 40960
    v_cmp_lt_u32 vcc, 31, v2
    v_mov_b32 v56, 0
    v_mov_b32 v57, 0
    v_mov_b32 v58, 0
    v_mov_b32 v59, 0
    v_mov_b32 v60, 0
    v_mov_b32 v61, 0
    v_mov_b32 v62, 0
    v_mov_b32 v63, 0
    v_mov_b32 v64, 0
    v_mov_b32 v65, 0
    v_mov_b32 v66, 0
    v_mov_b32 v67, 0
    v_mov_b32 v68, 0
    v_mov_b32 v69, 0
    v_mov_b32 v70, 0
    v_mov_b32 v71, 0
    v_mov_b32 v72, 0
    v_mov_b32 v73, 0
    v_mov_b32 v74, 0
    v_mov_b32 v75, 0
    v_mov_b32 v76, 0
    v_mov_b32 v77, 0
    v_mov_b32 v78, 0
    v_mov_b32 v79, 0
    v_mov_b32 v80, 0
    v_mov_b32 v81, 0
    v_mov_b32 v82, 0
    v_mov_b32 v83, 0
    v_mov_b32 v84, 0
    v_mov_b32 v85, 0
    v_mov_b32 v86, 0
    v_mov_b32 v87, 0
    v_mov_b32 v48, 0
    v_mov_b32 v49, 0
    v_mov_b32 v50, 0
    v_mov_b32 v51, 0
    v_mov_b32 v52, 0
    v_mov_b32 v53, 0
    v_mov_b32 v54, 0
    v_mov_b32 v55, 0
    v_mov_b32 v112, 0
    v_mov_b32 v113, 0
    v_mov_b32 v114, 0
    v_mov_b32 v115, 0
    v_mov_b32 v116, 0
    v_mov_b32 v117, 0
    v_mov_b32 v118, 0
    v_mov_b32 v119, 0
    v_mov_b32 v120, 0
    v_mov_b32 v121, 0
    v_mov_b32 v122, 0
    v_mov_b32 v123, 0
    v_mov_b32 v172, 0
    v_mov_b32 v173, 0
    v_mov_b32 v174, 0
    v_mov_b32 v175, 0
    v_mov_b32 v176, 0
    v_mov_b32 v177, 0
    v_mov_b32 v178, 0
    v_mov_b32 v179, 0
    v_mov_b32 v180, 0
    v_mov_b32 v181, 0
    v_mov_b32 v182, 0
    v_mov_b32 v183, 0
    v_mov_b32 v184, 0
    v_mov_b32 v185, 0
    v_mov_b32 v186, 0
    v_mov_b32 v187, 0
    v_mov_b32 v188, 0
    v_mov_b32 v189, 0
    v_mov_b32 v190, 0
    v_mov_b32 v191, 0
    v_mov_b32 v192, 0
    v_mov_b32 v193, 0
    v_mov_b32 v194, 0
    v_mov_b32 v195, 0
    v_mov_b32 v196, 0
    v_mov_b32 v197, 0
    v_mov_b32 v198, 0
    v_mov_b32 v199, 0
    v_mov_b32 v200, 0
    v_mov_b32 v201, 0
    v_mov_b32 v202, 0
    v_mov_b32 v203, 0
    v_mov_b32 v204, 0
    v_mov_b32 v205, 0
    v_mov_b32 v206, 0
    v_mov_b32 v207, 0
    v_mov_b32 v208, 0
    v_mov_b32 v209, 0
    v_mov_b32 v210, 0
    v_mov_b32 v211, 0
    v_mov_b32 v212, 0
    v_mov_b32 v213, 0
    v_mov_b32 v214, 0
    v_mov_b32 v215, 0
    v_mov_b32 v216, 0
    v_mov_b32 v217, 0
    v_mov_b32 v218, 0
    v_mov_b32 v219, 0
    v_mov_b32 v220, 0
    v_mov_b32 v221, 0
    v_mov_b32 v222, 0
    v_mov_b32 v223, 0
    v_mov_b32 v224, 0
    v_mov_b32 v225, 0
    v_mov_b32 v226, 0
    v_mov_b32 v227, 0
    v_mov_b32 v228, 0
    v_mov_b32 v229, 0
    v_mov_b32 v230, 0
    v_mov_b32 v231, 0
    v_mov_b32 v232, 0
    v_mov_b32 v233, 0
    v_mov_b32 v234, 0
    v_mov_b32 v235, 0
    v_mov_b32 v236, 0
    v_mov_b32 v237, 0
    v_mov_b32 v238, 0
    v_mov_b32 v239, 0
    v_mov_b32 v240, 0
    v_mov_b32 v241, 0
    v_mov_b32 v242, 0
    v_mov_b32 v243, 0
    v_mov_b32 v244, 0
    v_mov_b32 v245, 0
    v_mov_b32 v246, 0
    v_mov_b32 v247, 0
    v_mov_b32 v248, 0
    v_mov_b32 v249, 0
    v_mov_b32 v250, 0
    v_mov_b32 v251, 0
    s_barrier
    v_cmp_lt_u32 vcc, 31, v2
    s_mul_i32 s13, s21, 3072
    s_add_u32 s13, s13, 106496
    v_add_u32 v12, s13, v4
    v_add_u32 v13, s13, v9
    ds_read_b128 v[88:91], v12
    ds_read_b64 v[92:93], v13
    ds_read_b128 v[94:97], v12 offset:1280
    ds_read_b64 v[98:99], v13 offset:1280
    ds_read_b128 v[100:103], v5
    ds_read_b64 v[104:105], v6
    ds_read_b128 v[108:111], v5 offset:5120
    s_waitcnt lgkmcnt(0)
    v_cndmask_b32 v92, v92, v48, vcc
    v_cndmask_b32 v93, v93, v48, vcc
    v_cndmask_b32 v98, v98, v48, vcc
    v_cndmask_b32 v99, v99, v48, vcc
    s_nop 1
    v_mfma_f32_32x32x16_bf16 v[16:31], v[100:103], v[88:91], 0
    s_nop 7
    s_nop 3
    v_mfma_f32_32x32x8_bf16 v[16:31], v[104:105], v[92:93], v[16:31]
    s_nop 7
    s_nop 3
    s_mov_b32 s20, 0
.p2align 6
    v_mfma_f32_32x32x16_bf16 v[32:47], v[100:103], v[94:97], 0
    ds_read_b128 v[100:103], v5 offset:1280
    ds_read_b64 v[106:107], v6 offset:1280
    v_cvt_pk_bf16_f32 v54, v120, v121
    v_exp_f32 v116, v16
    v_exp_f32 v117, v17
    v_cvt_pk_bf16_f32 v55, v122, v123
    v_exp_f32 v118, v18
    v_exp_f32 v119, v19
    v_mfma_f32_32x32x16_bf16 v[72:87], v[112:115], v[52:55], v[72:87]
    ds_read_b128 v[112:115], v5 offset:6144
    v_cvt_pk_bf16_f32 v48, v116, v117
    v_exp_f32 v120, v20
    v_exp_f32 v121, v21
    v_cvt_pk_bf16_f32 v49, v118, v119
    v_exp_f32 v122, v22
    v_exp_f32 v123, v23
    v_mfma_f32_32x32x8_bf16 v[32:47], v[104:105], v[98:99], v[32:47]
    v_cvt_pk_bf16_f32 v50, v120, v121
    v_exp_f32 v116, v24
    v_exp_f32 v117, v25
    v_cvt_pk_bf16_f32 v51, v122, v123
    v_exp_f32 v118, v26
    v_exp_f32 v119, v27
    s_waitcnt lgkmcnt(3)
    v_mfma_f32_32x32x16_bf16 v[56:71], v[108:111], v[48:51], v[56:71]
    v_cvt_pk_bf16_f32 v52, v116, v117
    v_exp_f32 v120, v28
    v_exp_f32 v121, v29
    v_cvt_pk_bf16_f32 v53, v118, v119
    v_exp_f32 v122, v30
    v_exp_f32 v123, v31
    s_waitcnt lgkmcnt(0)
    v_mfma_f32_32x32x16_bf16 v[16:31], v[100:103], v[88:91], 0
    v_cvt_pk_bf16_f32 v54, v120, v121
    v_exp_f32 v116, v32
    v_exp_f32 v117, v33
    v_cvt_pk_bf16_f32 v55, v122, v123
    v_exp_f32 v118, v34
    v_exp_f32 v119, v35
    v_mfma_f32_32x32x16_bf16 v[56:71], v[112:115], v[52:55], v[56:71]
    v_cvt_pk_bf16_f32 v48, v116, v117
    v_exp_f32 v120, v36
    v_exp_f32 v121, v37
    v_cvt_pk_bf16_f32 v49, v118, v119
    v_exp_f32 v122, v38
    v_exp_f32 v123, v39
    v_mfma_f32_32x32x8_bf16 v[16:31], v[106:107], v[92:93], v[16:31]
    v_cvt_pk_bf16_f32 v50, v120, v121
    v_exp_f32 v116, v40
    v_exp_f32 v117, v41
    v_cvt_pk_bf16_f32 v51, v122, v123
    v_exp_f32 v118, v42
    v_exp_f32 v119, v43
    v_mfma_f32_32x32x16_bf16 v[72:87], v[108:111], v[48:51], v[72:87]
    ds_read_b128 v[108:111], v5 offset:7168
    v_cvt_pk_bf16_f32 v52, v116, v117
    v_exp_f32 v120, v44
    v_exp_f32 v121, v45
    v_cvt_pk_bf16_f32 v53, v118, v119
    v_exp_f32 v122, v46
    v_exp_f32 v123, v47
    v_mfma_f32_32x32x16_bf16 v[32:47], v[100:103], v[94:97], 0
    ds_read_b128 v[100:103], v5 offset:2560
    ds_read_b64 v[104:105], v6 offset:2560
    v_cvt_pk_bf16_f32 v54, v120, v121
    v_exp_f32 v116, v16
    v_exp_f32 v117, v17
    v_cvt_pk_bf16_f32 v55, v122, v123
    v_exp_f32 v118, v18
    v_exp_f32 v119, v19
    v_mfma_f32_32x32x16_bf16 v[72:87], v[112:115], v[52:55], v[72:87]
    ds_read_b128 v[112:115], v5 offset:8192
    v_cvt_pk_bf16_f32 v48, v116, v117
    v_exp_f32 v120, v20
    v_exp_f32 v121, v21
    v_cvt_pk_bf16_f32 v49, v118, v119
    v_exp_f32 v122, v22
    v_exp_f32 v123, v23
    v_mfma_f32_32x32x8_bf16 v[32:47], v[106:107], v[98:99], v[32:47]
    v_cvt_pk_bf16_f32 v50, v120, v121
    v_exp_f32 v116, v24
    v_exp_f32 v117, v25
    v_cvt_pk_bf16_f32 v51, v122, v123
    v_exp_f32 v118, v26
    v_exp_f32 v119, v27
    s_waitcnt lgkmcnt(3)
    v_mfma_f32_32x32x16_bf16 v[56:71], v[108:111], v[48:51], v[56:71]
    v_cvt_pk_bf16_f32 v52, v116, v117
    v_exp_f32 v120, v28
    v_exp_f32 v121, v29
    v_cvt_pk_bf16_f32 v53, v118, v119
    v_exp_f32 v122, v30
    v_exp_f32 v123, v31
    s_waitcnt lgkmcnt(0)
    v_mfma_f32_32x32x16_bf16 v[16:31], v[100:103], v[88:91], 0
    v_cvt_pk_bf16_f32 v54, v120, v121
    v_exp_f32 v116, v32
    v_exp_f32 v117, v33
    v_cvt_pk_bf16_f32 v55, v122, v123
    v_exp_f32 v118, v34
    v_exp_f32 v119, v35
    v_mfma_f32_32x32x16_bf16 v[56:71], v[112:115], v[52:55], v[56:71]
    v_cvt_pk_bf16_f32 v48, v116, v117
    v_exp_f32 v120, v36
    v_exp_f32 v121, v37
    v_cvt_pk_bf16_f32 v49, v118, v119
    v_exp_f32 v122, v38
    v_exp_f32 v123, v39
    v_mfma_f32_32x32x8_bf16 v[16:31], v[104:105], v[92:93], v[16:31]
    v_cvt_pk_bf16_f32 v50, v120, v121
    v_exp_f32 v116, v40
    v_exp_f32 v117, v41
    v_cvt_pk_bf16_f32 v51, v122, v123
    v_exp_f32 v118, v42
    v_exp_f32 v119, v43
    v_mfma_f32_32x32x16_bf16 v[72:87], v[108:111], v[48:51], v[72:87]
    ds_read_b128 v[108:111], v5 offset:9216
    v_cvt_pk_bf16_f32 v52, v116, v117
    v_exp_f32 v120, v44
    v_exp_f32 v121, v45
    v_cvt_pk_bf16_f32 v53, v118, v119
    v_exp_f32 v122, v46
    v_exp_f32 v123, v47
    v_mfma_f32_32x32x16_bf16 v[32:47], v[100:103], v[94:97], 0
    ds_read_b128 v[100:103], v5 offset:3840
    ds_read_b64 v[106:107], v6 offset:3840
    v_cvt_pk_bf16_f32 v54, v120, v121
    v_exp_f32 v116, v16
    v_exp_f32 v117, v17
    v_cvt_pk_bf16_f32 v55, v122, v123
    v_exp_f32 v118, v18
    v_exp_f32 v119, v19
    v_mfma_f32_32x32x16_bf16 v[72:87], v[112:115], v[52:55], v[72:87]
    ds_read_b128 v[112:115], v5 offset:10240
    v_cvt_pk_bf16_f32 v48, v116, v117
    v_exp_f32 v120, v20
    v_exp_f32 v121, v21
    v_cvt_pk_bf16_f32 v49, v118, v119
    v_exp_f32 v122, v22
    v_exp_f32 v123, v23
    v_mfma_f32_32x32x8_bf16 v[32:47], v[104:105], v[98:99], v[32:47]
    v_cvt_pk_bf16_f32 v50, v120, v121
    v_exp_f32 v116, v24
    v_exp_f32 v117, v25
    v_cvt_pk_bf16_f32 v51, v122, v123
    v_exp_f32 v118, v26
    v_exp_f32 v119, v27
    s_waitcnt lgkmcnt(3)
    v_mfma_f32_32x32x16_bf16 v[56:71], v[108:111], v[48:51], v[56:71]
    v_cvt_pk_bf16_f32 v52, v116, v117
    v_exp_f32 v120, v28
    v_exp_f32 v121, v29
    v_cvt_pk_bf16_f32 v53, v118, v119
    v_exp_f32 v122, v30
    v_exp_f32 v123, v31
    s_waitcnt lgkmcnt(0)
    v_mfma_f32_32x32x16_bf16 v[16:31], v[100:103], v[88:91], 0
    v_cvt_pk_bf16_f32 v54, v120, v121
    v_exp_f32 v116, v32
    v_exp_f32 v117, v33
    v_cvt_pk_bf16_f32 v55, v122, v123
    v_exp_f32 v118, v34
    v_exp_f32 v119, v35
    v_mfma_f32_32x32x16_bf16 v[56:71], v[112:115], v[52:55], v[56:71]
    v_cvt_pk_bf16_f32 v48, v116, v117
    v_exp_f32 v120, v36
    v_exp_f32 v121, v37
    v_cvt_pk_bf16_f32 v49, v118, v119
    v_exp_f32 v122, v38
    v_exp_f32 v123, v39
    v_mfma_f32_32x32x8_bf16 v[16:31], v[106:107], v[92:93], v[16:31]
    v_cvt_pk_bf16_f32 v50, v120, v121
    v_exp_f32 v116, v40
    v_exp_f32 v117, v41
    v_cvt_pk_bf16_f32 v51, v122, v123
    v_exp_f32 v118, v42
    v_exp_f32 v119, v43
    v_mfma_f32_32x32x16_bf16 v[72:87], v[108:111], v[48:51], v[72:87]
    ds_read_b128 v[108:111], v5 offset:11264
    v_cvt_pk_bf16_f32 v52, v116, v117
    v_exp_f32 v120, v44
    v_exp_f32 v121, v45
    v_cvt_pk_bf16_f32 v53, v118, v119
    v_exp_f32 v122, v46
    v_exp_f32 v123, v47
    s_waitcnt vmcnt(6)
    s_cmp_eq_u32 s71, -1
    s_cbranch_scc1 gated_mix__mha_block__glu_gated_geglu__prompt_kernel_pb_a
    s_cmp_lt_u32 s12, 4
    s_cbranch_scc0 gated_mix__mha_block__glu_gated_geglu__prompt_kernel_pb_a
    s_waitcnt vmcnt(0)
gated_mix__mha_block__glu_gated_geglu__prompt_kernel_pb_a:
    s_barrier
    s_cmp_eq_u32 s71, -1
    s_cbranch_scc1 gated_mix__mha_block__glu_gated_geglu__prompt_kernel_pb_b
    s_cmp_eq_u32 s12, 0
    s_cbranch_scc0 gated_mix__mha_block__glu_gated_geglu__prompt_kernel_pb_b
    v_mov_b32 v12, 162176
    ds_read_b32 v14, v12 offset:4
    s_lshr_b32 s60, s71, 8
    v_lshlrev_b32 v13, 3, v2
    v_add_u32 v13, s60, v13
    v_lshlrev_b32 v13, 9, v13
    s_and_b32 s60, s71, 0xff
    s_add_u32 s60, s60, 32
    s_lshl_b32 s60, s60, 2
    s_add_u32 s60, s60, 24182784
    s_waitcnt lgkmcnt(0)
    s_mov_b32 exec_hi, 0
    buffer_store_dword v14, v13, s[8:11], s60 offen sc1
    s_mov_b64 exec, -1
gated_mix__mha_block__glu_gated_geglu__prompt_kernel_pb_b:
    v_mfma_f32_32x32x16_bf16 v[32:47], v[100:103], v[94:97], 0
    ds_read_b128 v[100:103], v10 offset:0
    ds_read_b64 v[104:105], v11 offset:0
    v_cvt_pk_bf16_f32 v54, v120, v121
    v_exp_f32 v116, v16
    v_exp_f32 v117, v17
    s_cmp_ge_u32 s42, 8
    s_cselect_b32 s13, 0x7fff0000, 0
    s_add_u32 m0, s19, s41
    v_or_b32 v7, s13, v4
    buffer_load_dwordx4 v7, s[8:11], s18 offen offset:0 lds
    v_cvt_pk_bf16_f32 v55, v122, v123
    v_exp_f32 v118, v18
    v_exp_f32 v119, v19
    v_mfma_f32_32x32x16_bf16 v[72:87], v[112:115], v[52:55], v[72:87]
    ds_read_b128 v[112:115], v5 offset:12288
    v_cvt_pk_bf16_f32 v48, v116, v117
    v_exp_f32 v120, v20
    v_exp_f32 v121, v21
    v_cvt_pk_bf16_f32 v49, v118, v119
    v_exp_f32 v122, v22
    v_exp_f32 v123, v23
    v_mfma_f32_32x32x8_bf16 v[32:47], v[106:107], v[98:99], v[32:47]
    v_cvt_pk_bf16_f32 v50, v120, v121
    v_exp_f32 v116, v24
    v_exp_f32 v117, v25
    v_cvt_pk_bf16_f32 v51, v122, v123
    v_exp_f32 v118, v26
    buffer_load_dwordx4 v7, s[8:11], s18 offen offset:1024 lds
    v_exp_f32 v119, v27
    s_waitcnt lgkmcnt(3)
    v_mfma_f32_32x32x16_bf16 v[56:71], v[108:111], v[48:51], v[56:71]
    v_cvt_pk_bf16_f32 v52, v116, v117
    v_exp_f32 v120, v28
    v_exp_f32 v121, v29
    v_cvt_pk_bf16_f32 v53, v118, v119
    v_exp_f32 v122, v30
    v_exp_f32 v123, v31
    s_waitcnt lgkmcnt(0)
    v_mfma_f32_32x32x16_bf16 v[16:31], v[100:103], v[88:91], 0
    v_cvt_pk_bf16_f32 v54, v120, v121
    v_exp_f32 v116, v32
    v_exp_f32 v117, v33
    buffer_load_dwordx4 v7, s[8:11], s18 offen offset:2048 lds
    v_cvt_pk_bf16_f32 v55, v122, v123
    v_exp_f32 v118, v34
    v_exp_f32 v119, v35
    v_mfma_f32_32x32x16_bf16 v[56:71], v[112:115], v[52:55], v[56:71]
    v_cvt_pk_bf16_f32 v48, v116, v117
    v_exp_f32 v120, v36
    v_exp_f32 v121, v37
    v_cvt_pk_bf16_f32 v49, v118, v119
    v_exp_f32 v122, v38
    v_exp_f32 v123, v39
    v_mfma_f32_32x32x8_bf16 v[16:31], v[104:105], v[92:93], v[16:31]
    v_cvt_pk_bf16_f32 v50, v120, v121
    v_exp_f32 v116, v40
    v_exp_f32 v117, v41
    v_cvt_pk_bf16_f32 v51, v122, v123
    v_exp_f32 v118, v42
    s_cmp_eq_u32 s21, 3
    s_cbranch_scc0 gated_mix__mha_block__glu_gated_geglu__prompt_kernel_p2_nd_7
    buffer_load_dwordx4 v7, s[8:11], s18 offen offset:3072 lds
gated_mix__mha_block__glu_gated_geglu__prompt_kernel_p2_nd_7:
    s_add_u32 s18, s18, 13312
    s_add_u32 s42, s42, 1
    s_add_u32 s41, s41, 13312
    s_cmp_eq_u32 s41, 53248
    s_cselect_b32 s41, 0, s41
    v_exp_f32 v119, v43
    v_mfma_f32_32x32x16_bf16 v[72:87], v[108:111], v[48:51], v[72:87]
    ds_read_b128 v[108:111], v10 offset:5120
    v_cvt_pk_bf16_f32 v52, v116, v117
    v_exp_f32 v120, v44
    v_exp_f32 v121, v45
    v_cvt_pk_bf16_f32 v53, v118, v119
    v_exp_f32 v122, v46
    v_exp_f32 v123, v47
    v_add_u32 v5, s40, v5
    v_add_u32 v6, s40, v6
    v_mfma_f32_32x32x16_bf16 v[32:47], v[100:103], v[94:97], 0
    ds_read_b128 v[100:103], v10 offset:1280
    ds_read_b64 v[106:107], v11 offset:1280
    v_cvt_pk_bf16_f32 v54, v120, v121
    v_exp_f32 v116, v16
    v_exp_f32 v117, v17
    v_cvt_pk_bf16_f32 v55, v122, v123
    v_exp_f32 v118, v18
    v_exp_f32 v119, v19
    v_mfma_f32_32x32x16_bf16 v[72:87], v[112:115], v[52:55], v[72:87]
    ds_read_b128 v[112:115], v10 offset:6144
    v_cvt_pk_bf16_f32 v48, v116, v117
    v_exp_f32 v120, v20
    v_exp_f32 v121, v21
    v_cvt_pk_bf16_f32 v49, v118, v119
    v_exp_f32 v122, v22
    v_exp_f32 v123, v23
    v_mfma_f32_32x32x8_bf16 v[32:47], v[104:105], v[98:99], v[32:47]
    v_cvt_pk_bf16_f32 v50, v120, v121
    v_exp_f32 v116, v24
    v_exp_f32 v117, v25
    v_cvt_pk_bf16_f32 v51, v122, v123
    v_exp_f32 v118, v26
    v_exp_f32 v119, v27
    s_waitcnt lgkmcnt(3)
    v_mfma_f32_32x32x16_bf16 v[56:71], v[108:111], v[48:51], v[56:71]
    v_cvt_pk_bf16_f32 v52, v116, v117
    v_exp_f32 v120, v28
    v_exp_f32 v121, v29
    v_cvt_pk_bf16_f32 v53, v118, v119
    v_exp_f32 v122, v30
    v_exp_f32 v123, v31
    s_waitcnt lgkmcnt(0)
    v_mfma_f32_32x32x16_bf16 v[16:31], v[100:103], v[88:91], 0
    v_cvt_pk_bf16_f32 v54, v120, v121
    v_exp_f32 v116, v32
    v_exp_f32 v117, v33
    v_cvt_pk_bf16_f32 v55, v122, v123
    v_exp_f32 v118, v34
    v_exp_f32 v119, v35
    v_mfma_f32_32x32x16_bf16 v[56:71], v[112:115], v[52:55], v[56:71]
    v_cvt_pk_bf16_f32 v48, v116, v117
    v_exp_f32 v120, v36
    v_exp_f32 v121, v37
    v_cvt_pk_bf16_f32 v49, v118, v119
    v_exp_f32 v122, v38
    v_exp_f32 v123, v39
    v_mfma_f32_32x32x8_bf16 v[16:31], v[106:107], v[92:93], v[16:31]
    v_cvt_pk_bf16_f32 v50, v120, v121
    v_exp_f32 v116, v40
    v_exp_f32 v117, v41
    v_cvt_pk_bf16_f32 v51, v122, v123
    v_exp_f32 v118, v42
    v_exp_f32 v119, v43
    v_mfma_f32_32x32x16_bf16 v[72:87], v[108:111], v[48:51], v[72:87]
    ds_read_b128 v[108:111], v10 offset:7168
    v_cvt_pk_bf16_f32 v52, v116, v117
    v_exp_f32 v120, v44
    v_exp_f32 v121, v45
    v_cvt_pk_bf16_f32 v53, v118, v119
    v_exp_f32 v122, v46
    v_exp_f32 v123, v47
    v_mfma_f32_32x32x16_bf16 v[32:47], v[100:103], v[94:97], 0
    ds_read_b128 v[100:103], v10 offset:2560
    ds_read_b64 v[104:105], v11 offset:2560
    v_cvt_pk_bf16_f32 v54, v120, v121
    v_exp_f32 v116, v16
    v_exp_f32 v117, v17
    v_cvt_pk_bf16_f32 v55, v122, v123
    v_exp_f32 v118, v18
    v_exp_f32 v119, v19
    v_mfma_f32_32x32x16_bf16 v[72:87], v[112:115], v[52:55], v[72:87]
    ds_read_b128 v[112:115], v10 offset:8192
    v_cvt_pk_bf16_f32 v48, v116, v117
    v_exp_f32 v120, v20
    v_exp_f32 v121, v21
    v_cvt_pk_bf16_f32 v49, v118, v119
    v_exp_f32 v122, v22
    v_exp_f32 v123, v23
    v_mfma_f32_32x32x8_bf16 v[32:47], v[106:107], v[98:99], v[32:47]
    v_cvt_pk_bf16_f32 v50, v120, v121
    v_exp_f32 v116, v24
    v_exp_f32 v117, v25
    v_cvt_pk_bf16_f32 v51, v122, v123
    v_exp_f32 v118, v26
    v_exp_f32 v119, v27
    s_waitcnt lgkmcnt(3)
    v_mfma_f32_32x32x16_bf16 v[56:71], v[108:111], v[48:51], v[56:71]
    v_cvt_pk_bf16_f32 v52, v116, v117
    v_exp_f32 v120, v28
    v_exp_f32 v121, v29
    v_cvt_pk_bf16_f32 v53, v118, v119
    v_exp_f32 v122, v30
    v_exp_f32 v123, v31
    s_cmp_eq_u32 s12, 0
    s_cbranch_scc0 gated_mix__mha_block__glu_gated_geglu__prompt_kernel_gate_ni
    v_mov_b32 v12, 162176
    ds_read_b32 v14, v12 offset:4
    v_cmp_gt_u32 vcc, 16, v2
    v_add_u32 v13, 48, v2
    v_add_u32 v12, 32, v2
    v_cndmask_b32 v13, v13, v12, vcc
    v_lshlrev_b32 v13, 2, v13
    s_lshl_b32 s60, s2, 9
    s_add_u32 s60, s60, 24182784
    v_add_u32 v13, s60, v13
    s_mov_b32 exec_hi, 0xffff
    buffer_load_dword v15, v13, s[8:11], 0 offen sc1
    s_mov_b64 exec, -1
gated_mix__mha_block__glu_gated_geglu__prompt_kernel_gate_ni:
    s_waitcnt lgkmcnt(0)
    v_mfma_f32_32x32x16_bf16 v[16:31], v[100:103], v[88:91], 0
    v_cvt_pk_bf16_f32 v54, v120, v121
    v_exp_f32 v116, v32
    v_exp_f32 v117, v33
    v_cvt_pk_bf16_f32 v55, v122, v123
    v_exp_f32 v118, v34
    v_exp_f32 v119, v35
    v_mfma_f32_32x32x16_bf16 v[56:71], v[112:115], v[52:55], v[56:71]
    v_cvt_pk_bf16_f32 v48, v116, v117
    v_exp_f32 v120, v36
    v_exp_f32 v121, v37
    v_cvt_pk_bf16_f32 v49, v118, v119
    v_exp_f32 v122, v38
    v_exp_f32 v123, v39
    v_mfma_f32_32x32x8_bf16 v[16:31], v[104:105], v[92:93], v[16:31]
    v_cvt_pk_bf16_f32 v50, v120, v121
    v_exp_f32 v116, v40
    v_exp_f32 v117, v41
    v_cvt_pk_bf16_f32 v51, v122, v123
    v_exp_f32 v118, v42
    v_exp_f32 v119, v43
    v_mfma_f32_32x32x16_bf16 v[72:87], v[108:111], v[48:51], v[72:87]
    ds_read_b128 v[108:111], v10 offset:9216
    v_cvt_pk_bf16_f32 v52, v116, v117
    v_exp_f32 v120, v44
    v_exp_f32 v121, v45
    v_cvt_pk_bf16_f32 v53, v118, v119
    v_exp_f32 v122, v46
    v_exp_f32 v123, v47
    v_mfma_f32_32x32x16_bf16 v[32:47], v[100:103], v[94:97], 0
    ds_read_b128 v[100:103], v10 offset:3840
    ds_read_b64 v[106:107], v11 offset:3840
    v_cvt_pk_bf16_f32 v54, v120, v121
    v_exp_f32 v116, v16
    v_exp_f32 v117, v17
    v_cvt_pk_bf16_f32 v55, v122, v123
    v_exp_f32 v118, v18
    v_exp_f32 v119, v19
    v_mfma_f32_32x32x16_bf16 v[72:87], v[112:115], v[52:55], v[72:87]
    ds_read_b128 v[112:115], v10 offset:10240
    v_cvt_pk_bf16_f32 v48, v116, v117
    v_exp_f32 v120, v20
    v_exp_f32 v121, v21
    v_cvt_pk_bf16_f32 v49, v118, v119
    v_exp_f32 v122, v22
    v_exp_f32 v123, v23
    v_mfma_f32_32x32x8_bf16 v[32:47], v[104:105], v[98:99], v[32:47]
    v_cvt_pk_bf16_f32 v50, v120, v121
    v_exp_f32 v116, v24
    v_exp_f32 v117, v25
    v_cvt_pk_bf16_f32 v51, v122, v123
    v_exp_f32 v118, v26
    v_exp_f32 v119, v27
    s_waitcnt lgkmcnt(3)
    v_mfma_f32_32x32x16_bf16 v[56:71], v[108:111], v[48:51], v[56:71]
    v_cvt_pk_bf16_f32 v52, v116, v117
    v_exp_f32 v120, v28
    v_exp_f32 v121, v29
    v_cvt_pk_bf16_f32 v53, v118, v119
    v_exp_f32 v122, v30
    v_exp_f32 v123, v31
    s_waitcnt lgkmcnt(0)
    v_mfma_f32_32x32x16_bf16 v[16:31], v[100:103], v[88:91], 0
    v_cvt_pk_bf16_f32 v54, v120, v121
    v_exp_f32 v116, v32
    v_exp_f32 v117, v33
    v_cvt_pk_bf16_f32 v55, v122, v123
    v_exp_f32 v118, v34
    v_exp_f32 v119, v35
    v_mfma_f32_32x32x16_bf16 v[56:71], v[112:115], v[52:55], v[56:71]
    v_cvt_pk_bf16_f32 v48, v116, v117
    v_exp_f32 v120, v36
    v_exp_f32 v121, v37
    v_cvt_pk_bf16_f32 v49, v118, v119
    v_exp_f32 v122, v38
    v_exp_f32 v123, v39
    v_mfma_f32_32x32x8_bf16 v[16:31], v[106:107], v[92:93], v[16:31]
    v_cvt_pk_bf16_f32 v50, v120, v121
    v_exp_f32 v116, v40
    v_exp_f32 v117, v41
    v_cvt_pk_bf16_f32 v51, v122, v123
    v_exp_f32 v118, v42
    v_exp_f32 v119, v43
    v_mfma_f32_32x32x16_bf16 v[72:87], v[108:111], v[48:51], v[72:87]
    ds_read_b128 v[108:111], v10 offset:11264
    v_cvt_pk_bf16_f32 v52, v116, v117
    v_exp_f32 v120, v44
    v_exp_f32 v121, v45
    v_cvt_pk_bf16_f32 v53, v118, v119
    v_exp_f32 v122, v46
    v_exp_f32 v123, v47
    s_waitcnt vmcnt(3)
    s_cmp_eq_u32 s12, 0
    s_cbranch_scc0 gated_mix__mha_block__glu_gated_geglu__prompt_kernel_gate_ok
    s_waitcnt vmcnt(0) lgkmcnt(0)
    s_mov_b32 exec_hi, 0xffff
    v_cmp_ne_u32 vcc, v15, v14
    s_nop 1
    s_cbranch_vccz gated_mix__mha_block__glu_gated_geglu__prompt_kernel_gate_pass
    s_mov_b32 s60, 0
gated_mix__mha_block__glu_gated_geglu__prompt_kernel_gatep_poll:
    buffer_load_dword v15, v13, s[8:11], 0 offen sc1
    s_waitcnt vmcnt(0)
    v_cmp_ne_u32 vcc, v15, v14
    s_add_u32 s60, s60, 1
    s_nop 1
    s_cbranch_vccz gated_mix__mha_block__glu_gated_geglu__prompt_kernel_gatep_done
    s_sleep 8
    s_cmp_lt_u32 s60, 0x40000
    s_cbranch_scc1 gated_mix__mha_block__glu_gated_geglu__prompt_kernel_gatep_poll
gated_mix__mha_block__glu_gated_geglu__prompt_kernel_gatep_done:
gated_mix__mha_block__glu_gated_geglu__prompt_kernel_gate_pass:
    s_mov_b64 exec, -1
gated_mix__mha_block__glu_gated_geglu__prompt_kernel_gate_ok:
    s_barrier
    v_mfma_f32_32x32x16_bf16 v[32:47], v[100:103], v[94:97], 0
    ds_read_b128 v[100:103], v5 offset:0
    ds_read_b64 v[104:105], v6 offset:0
    v_cvt_pk_bf16_f32 v54, v120, v121
    v_exp_f32 v116, v16
    v_exp_f32 v117, v17
    s_cmp_ge_u32 s42, 8
    s_cselect_b32 s13, 0x7fff0000, 0
    s_add_u32 m0, s19, s41
    v_or_b32 v7, s13, v4
    buffer_load_dwordx4 v7, s[8:11], s18 offen offset:0 lds
    v_cvt_pk_bf16_f32 v55, v122, v123
    v_exp_f32 v118, v18
    v_exp_f32 v119, v19
    v_mfma_f32_32x32x16_bf16 v[72:87], v[112:115], v[52:55], v[72:87]
    ds_read_b128 v[112:115], v10 offset:12288
    v_cvt_pk_bf16_f32 v48, v116, v117
    v_exp_f32 v120, v20
    v_lshlrev_b32 v14, 2, v3
    s_add_u32 s13, s17, s22
    s_lshl_b32 s13, s13, 7
    s_add_u32 s13, s13, 24117248
    buffer_load_dword v252, v14, s[8:11], s13 offen
    s_lshl_b32 s13, s23, 7
    s_add_u32 s13, s13, 24117248
    buffer_load_dword v253, v14, s[8:11], s13 offen
    v_exp_f32 v121, v21
    v_cvt_pk_bf16_f32 v49, v118, v119
    buffer_load_dwordx4 v[144:147], v8, s[8:11], s31 offen offset:0
    v_exp_f32 v122, v22
    v_exp_f32 v123, v23
    buffer_load_dwordx4 v[124:127], v8, s[8:11], s26 offen offset:0
    v_mfma_f32_32x32x8_bf16 v[32:47], v[106:107], v[98:99], v[32:47]
    v_cvt_pk_bf16_f32 v50, v120, v121
    v_exp_f32 v116, v24
    buffer_load_dwordx4 v[128:131], v8, s[8:11], s27 offen offset:0
    v_exp_f32 v117, v25
    v_cvt_pk_bf16_f32 v51, v122, v123
    v_exp_f32 v118, v26
    buffer_load_dwordx4 v7, s[8:11], s18 offen offset:1024 lds
    v_exp_f32 v119, v27
    s_waitcnt lgkmcnt(3)
    v_mfma_f32_32x32x16_bf16 v[56:71], v[108:111], v[48:51], v[56:71]
    v_cvt_pk_bf16_f32 v52, v116, v117
    v_exp_f32 v120, v28
    buffer_load_dwordx4 v[132:135], v8, s[8:11], s28 offen offset:0
    v_exp_f32 v121, v29
    v_cvt_pk_bf16_f32 v53, v118, v119
    buffer_load_dwordx4 v[136:139], v8, s[8:11], s29 offen offset:0
    v_exp_f32 v122, v30
    v_exp_f32 v123, v31
    v_add_u32 v10, s40, v10
    v_add_u32 v11, s40, v11
    s_waitcnt lgkmcnt(0)
    v_mfma_f32_32x32x16_bf16 v[16:31], v[100:103], v[88:91], 0
    v_cvt_pk_bf16_f32 v54, v120, v121
    buffer_load_dwordx4 v[140:143], v8, s[8:11], s30 offen offset:0
    v_exp_f32 v116, v32
    v_exp_f32 v117, v33
    buffer_load_dwordx4 v7, s[8:11], s18 offen offset:2048 lds
    v_cvt_pk_bf16_f32 v55, v122, v123
    v_exp_f32 v118, v34
    buffer_load_dwordx4 v[168:171], v8, s[8:11], s31 offen offset:1024
    v_exp_f32 v119, v35
    v_mfma_f32_32x32x16_bf16 v[56:71], v[112:115], v[52:55], v[56:71]
    v_cvt_pk_bf16_f32 v48, v116, v117
    v_exp_f32 v120, v36
    buffer_load_dwordx4 v[148:151], v8, s[8:11], s26 offen offset:1024
    v_exp_f32 v121, v37
    v_cvt_pk_bf16_f32 v49, v118, v119
    buffer_load_dwordx4 v[152:155], v8, s[8:11], s27 offen offset:1024
    v_exp_f32 v122, v38
    v_exp_f32 v123, v39
    v_mfma_f32_32x32x8_bf16 v[16:31], v[104:105], v[92:93], v[16:31]
    v_cvt_pk_bf16_f32 v50, v120, v121
    v_exp_f32 v116, v40
    buffer_load_dwordx4 v[156:159], v8, s[8:11], s28 offen offset:1024
    v_exp_f32 v117, v41
    v_cvt_pk_bf16_f32 v51, v122, v123
    v_exp_f32 v118, v42
    s_cmp_eq_u32 s21, 3
    s_cbranch_scc0 gated_mix__mha_block__glu_gated_geglu__prompt_kernel_p2_nd_8
    buffer_load_dwordx4 v7, s[8:11], s18 offen offset:3072 lds
gated_mix__mha_block__glu_gated_geglu__prompt_kernel_p2_nd_8:
    s_add_u32 s18, s18, 13312
    s_add_u32 s42, s42, 1
    s_add_u32 s41, s41, 13312
    s_cmp_eq_u32 s41, 53248
    s_cselect_b32 s41, 0, s41
    v_exp_f32 v119, v43
    v_mfma_f32_32x32x16_bf16 v[72:87], v[108:111], v[48:51], v[72:87]
    ds_read_b128 v[108:111], v5 offset:5120
    v_cvt_pk_bf16_f32 v52, v116, v117
    v_exp_f32 v120, v44
    buffer_load_dwordx4 v[160:163], v8, s[8:11], s29 offen offset:1024
    v_exp_f32 v121, v45
    v_cvt_pk_bf16_f32 v53, v118, v119
    buffer_load_dwordx4 v[164:167], v8, s[8:11], s30 offen offset:1024
    v_exp_f32 v122, v46
    v_exp_f32 v123, v47
    v_add_u32 v8, 2048, v8
    s_sub_u32 s40, 0, s40
    s_mov_b32 s20, 0
.p2align 6
gated_mix__mha_block__glu_gated_geglu__prompt_kernel_p2_aloop:
    v_mfma_f32_32x32x16_bf16 v[32:47], v[100:103], v[94:97], 0
    ds_read_b128 v[100:103], v5 offset:1280
    ds_read_b64 v[106:107], v6 offset:1280
    v_cvt_pk_bf16_f32 v54, v120, v121
    v_exp_f32 v116, v16
    v_exp_f32 v117, v17
    v_cvt_pk_bf16_f32 v55, v122, v123
    v_exp_f32 v118, v18
    v_exp_f32 v119, v19
    v_mfma_f32_32x32x16_bf16 v[72:87], v[112:115], v[52:55], v[72:87]
    ds_read_b128 v[112:115], v5 offset:6144
    v_cvt_pk_bf16_f32 v48, v116, v117
    v_exp_f32 v120, v20
    v_exp_f32 v121, v21
    v_cvt_pk_bf16_f32 v49, v118, v119
    v_exp_f32 v122, v22
    v_exp_f32 v123, v23
    v_mfma_f32_32x32x8_bf16 v[32:47], v[104:105], v[98:99], v[32:47]
    v_cvt_pk_bf16_f32 v50, v120, v121
    v_exp_f32 v116, v24
    v_exp_f32 v117, v25
    v_cvt_pk_bf16_f32 v51, v122, v123
    v_exp_f32 v118, v26
    v_exp_f32 v119, v27
    s_waitcnt lgkmcnt(3)
    v_mfma_f32_32x32x16_bf16 v[56:71], v[108:111], v[48:51], v[56:71]
    v_cvt_pk_bf16_f32 v52, v116, v117
    v_exp_f32 v120, v28
    v_exp_f32 v121, v29
    v_cvt_pk_bf16_f32 v53, v118, v119
    v_exp_f32 v122, v30
    v_exp_f32 v123, v31
    s_waitcnt lgkmcnt(0)
    v_mfma_f32_32x32x16_bf16 v[16:31], v[100:103], v[88:91], 0
    v_cvt_pk_bf16_f32 v54, v120, v121
    v_exp_f32 v116, v32
    v_exp_f32 v117, v33
    v_cvt_pk_bf16_f32 v55, v122, v123
    v_exp_f32 v118, v34
    v_exp_f32 v119, v35
    v_mfma_f32_32x32x16_bf16 v[56:71], v[112:115], v[52:55], v[56:71]
    v_cvt_pk_bf16_f32 v48, v116, v117
    v_exp_f32 v120, v36
    v_exp_f32 v121, v37
    v_cvt_pk_bf16_f32 v49, v118, v119
    v_exp_f32 v122, v38
    v_exp_f32 v123, v39
    v_mfma_f32_32x32x8_bf16 v[16:31], v[106:107], v[92:93], v[16:31]
    v_cvt_pk_bf16_f32 v50, v120, v121
    v_exp_f32 v116, v40
    v_exp_f32 v117, v41
    v_cvt_pk_bf16_f32 v51, v122, v123
    v_exp_f32 v118, v42
    v_exp_f32 v119, v43
    v_mfma_f32_32x32x16_bf16 v[72:87], v[108:111], v[48:51], v[72:87]
    ds_read_b128 v[108:111], v5 offset:7168
    v_cvt_pk_bf16_f32 v52, v116, v117
    v_exp_f32 v120, v44
    v_exp_f32 v121, v45
    v_cvt_pk_bf16_f32 v53, v118, v119
    v_exp_f32 v122, v46
    v_exp_f32 v123, v47
    v_mfma_f32_32x32x16_bf16 v[32:47], v[100:103], v[94:97], 0
    ds_read_b128 v[100:103], v5 offset:2560
    ds_read_b64 v[104:105], v6 offset:2560
    v_cvt_pk_bf16_f32 v54, v120, v121
    v_exp_f32 v116, v16
    v_exp_f32 v117, v17
    v_cvt_pk_bf16_f32 v55, v122, v123
    v_exp_f32 v118, v18
    s_waitcnt vmcnt(7)
    v_mfma_f32_32x32x16_bf16 v[172:187], v[124:127], v[144:147], v[172:187]
    buffer_load_dwordx4 v[124:127], v8, s[8:11], s26 offen offset:0
    v_exp_f32 v119, v19
    v_cvt_pk_bf16_f32 v48, v116, v117
    v_exp_f32 v120, v20
    v_exp_f32 v121, v21
    v_cvt_pk_bf16_f32 v49, v118, v119
    v_mfma_f32_32x32x16_bf16 v[72:87], v[112:115], v[52:55], v[72:87]
    ds_read_b128 v[112:115], v5 offset:8192
    v_exp_f32 v122, v22
    v_exp_f32 v123, v23
    v_cvt_pk_bf16_f32 v50, v120, v121
    v_exp_f32 v116, v24
    v_mfma_f32_32x32x8_bf16 v[32:47], v[106:107], v[98:99], v[32:47]
    v_exp_f32 v117, v25
    v_cvt_pk_bf16_f32 v51, v122, v123
    v_exp_f32 v118, v26
    v_exp_f32 v119, v27
    v_cvt_pk_bf16_f32 v52, v116, v117
    s_waitcnt lgkmcnt(3)
    v_mfma_f32_32x32x16_bf16 v[56:71], v[108:111], v[48:51], v[56:71]
    v_exp_f32 v120, v28
    v_exp_f32 v121, v29
    v_cvt_pk_bf16_f32 v53, v118, v119
    v_exp_f32 v122, v30
    v_exp_f32 v123, v31
    s_waitcnt lgkmcnt(0)
    v_mfma_f32_32x32x16_bf16 v[16:31], v[100:103], v[88:91], 0
    v_cvt_pk_bf16_f32 v54, v120, v121
    v_exp_f32 v116, v32
    v_exp_f32 v117, v33
    v_cvt_pk_bf16_f32 v55, v122, v123
    v_exp_f32 v118, v34
    v_mfma_f32_32x32x16_bf16 v[188:203], v[128:131], v[144:147], v[188:203]
    buffer_load_dwordx4 v[128:131], v8, s[8:11], s27 offen offset:0
    v_exp_f32 v119, v35
    v_cvt_pk_bf16_f32 v48, v116, v117
    v_exp_f32 v120, v36
    v_exp_f32 v121, v37
    v_cvt_pk_bf16_f32 v49, v118, v119
    v_mfma_f32_32x32x16_bf16 v[56:71], v[112:115], v[52:55], v[56:71]
    v_exp_f32 v122, v38
    v_exp_f32 v123, v39
    v_cvt_pk_bf16_f32 v50, v120, v121
    v_exp_f32 v116, v40
    v_mfma_f32_32x32x8_bf16 v[16:31], v[104:105], v[92:93], v[16:31]
    v_exp_f32 v117, v41
    v_cvt_pk_bf16_f32 v51, v122, v123
    v_exp_f32 v118, v42
    v_exp_f32 v119, v43
    v_cvt_pk_bf16_f32 v52, v116, v117
    v_mfma_f32_32x32x16_bf16 v[72:87], v[108:111], v[48:51], v[72:87]
    ds_read_b128 v[108:111], v5 offset:9216
    v_exp_f32 v120, v44
    v_exp_f32 v121, v45
    v_cvt_pk_bf16_f32 v53, v118, v119
    v_exp_f32 v122, v46
    v_exp_f32 v123, v47
    v_mfma_f32_32x32x16_bf16 v[32:47], v[100:103], v[94:97], 0
    ds_read_b128 v[100:103], v5 offset:3840
    ds_read_b64 v[106:107], v6 offset:3840
    v_cvt_pk_bf16_f32 v54, v120, v121
    v_exp_f32 v116, v16
    v_exp_f32 v117, v17
    v_cvt_pk_bf16_f32 v55, v122, v123
    v_mfma_f32_32x32x16_bf16 v[204:219], v[132:135], v[144:147], v[204:219]
    buffer_load_dwordx4 v[132:135], v8, s[8:11], s28 offen offset:0
    v_exp_f32 v118, v18
    v_exp_f32 v119, v19
    v_cvt_pk_bf16_f32 v48, v116, v117
    v_exp_f32 v120, v20
    v_mfma_f32_32x32x16_bf16 v[72:87], v[112:115], v[52:55], v[72:87]
    ds_read_b128 v[112:115], v5 offset:10240
    v_exp_f32 v121, v21
    v_cvt_pk_bf16_f32 v49, v118, v119
    v_exp_f32 v122, v22
    v_exp_f32 v123, v23
    v_mfma_f32_32x32x8_bf16 v[32:47], v[104:105], v[98:99], v[32:47]
    v_cvt_pk_bf16_f32 v50, v120, v121
    v_exp_f32 v116, v24
    v_exp_f32 v117, v25
    v_cvt_pk_bf16_f32 v51, v122, v123
    v_mfma_f32_32x32x16_bf16 v[220:235], v[136:139], v[144:147], v[220:235]
    buffer_load_dwordx4 v[136:139], v8, s[8:11], s29 offen offset:0
    v_exp_f32 v118, v26
    v_exp_f32 v119, v27
    v_cvt_pk_bf16_f32 v52, v116, v117
    v_exp_f32 v120, v28
    s_waitcnt lgkmcnt(3)
    v_mfma_f32_32x32x16_bf16 v[56:71], v[108:111], v[48:51], v[56:71]
    v_exp_f32 v121, v29
    v_cvt_pk_bf16_f32 v53, v118, v119
    v_exp_f32 v122, v30
    v_exp_f32 v123, v31
    s_waitcnt lgkmcnt(0)
    v_mfma_f32_32x32x16_bf16 v[16:31], v[100:103], v[88:91], 0
    v_cvt_pk_bf16_f32 v54, v120, v121
    v_exp_f32 v116, v32
    v_exp_f32 v117, v33
    v_cvt_pk_bf16_f32 v55, v122, v123
    v_exp_f32 v118, v34
    v_mfma_f32_32x32x16_bf16 v[236:251], v[140:143], v[144:147], v[236:251]
    buffer_load_dwordx4 v[140:143], v8, s[8:11], s30 offen offset:0
    buffer_load_dwordx4 v[144:147], v8, s[8:11], s31 offen offset:0
    v_exp_f32 v119, v35
    v_cvt_pk_bf16_f32 v48, v116, v117
    v_exp_f32 v120, v36
    v_exp_f32 v121, v37
    v_cvt_pk_bf16_f32 v49, v118, v119
    v_mfma_f32_32x32x16_bf16 v[56:71], v[112:115], v[52:55], v[56:71]
    v_exp_f32 v122, v38
    v_exp_f32 v123, v39
    v_cvt_pk_bf16_f32 v50, v120, v121
    v_exp_f32 v116, v40
    v_mfma_f32_32x32x8_bf16 v[16:31], v[106:107], v[92:93], v[16:31]
    v_exp_f32 v117, v41
    v_cvt_pk_bf16_f32 v51, v122, v123
    v_exp_f32 v118, v42
    v_exp_f32 v119, v43
    v_cvt_pk_bf16_f32 v52, v116, v117
    v_mfma_f32_32x32x16_bf16 v[72:87], v[108:111], v[48:51], v[72:87]
    ds_read_b128 v[108:111], v5 offset:11264
    v_exp_f32 v120, v44
    v_exp_f32 v121, v45
    v_cvt_pk_bf16_f32 v53, v118, v119
    v_exp_f32 v122, v46
    v_exp_f32 v123, v47
    s_waitcnt vmcnt(23)
    s_barrier
    v_mfma_f32_32x32x16_bf16 v[32:47], v[100:103], v[94:97], 0
    ds_read_b128 v[100:103], v10 offset:0
    ds_read_b64 v[104:105], v11 offset:0
    v_cvt_pk_bf16_f32 v54, v120, v121
    v_exp_f32 v116, v16
    v_exp_f32 v117, v17
    s_cmp_ge_u32 s42, 8
    s_cselect_b32 s13, 0x7fff0000, 0
    s_add_u32 m0, s19, s41
    v_or_b32 v7, s13, v4
    buffer_load_dwordx4 v7, s[8:11], s18 offen offset:0 lds
    v_cvt_pk_bf16_f32 v55, v122, v123
    s_waitcnt vmcnt(7)
    v_mfma_f32_32x32x16_bf16 v[172:187], v[148:151], v[168:171], v[172:187]
    buffer_load_dwordx4 v[148:151], v8, s[8:11], s26 offen offset:1024
    v_exp_f32 v118, v18
    v_exp_f32 v119, v19
    v_cvt_pk_bf16_f32 v48, v116, v117
    v_exp_f32 v120, v20
    v_mfma_f32_32x32x16_bf16 v[72:87], v[112:115], v[52:55], v[72:87]
    ds_read_b128 v[112:115], v5 offset:12288
    v_exp_f32 v121, v21
    v_cvt_pk_bf16_f32 v49, v118, v119
    v_exp_f32 v122, v22
    v_exp_f32 v123, v23
    v_mfma_f32_32x32x8_bf16 v[32:47], v[106:107], v[98:99], v[32:47]
    v_cvt_pk_bf16_f32 v50, v120, v121
    v_exp_f32 v116, v24
    v_exp_f32 v117, v25
    v_cvt_pk_bf16_f32 v51, v122, v123
    v_mfma_f32_32x32x16_bf16 v[188:203], v[152:155], v[168:171], v[188:203]
    buffer_load_dwordx4 v[152:155], v8, s[8:11], s27 offen offset:1024
    v_exp_f32 v118, v26
    buffer_load_dwordx4 v7, s[8:11], s18 offen offset:1024 lds
    v_exp_f32 v119, v27
    v_cvt_pk_bf16_f32 v52, v116, v117
    v_exp_f32 v120, v28
    s_waitcnt lgkmcnt(3)
    v_mfma_f32_32x32x16_bf16 v[56:71], v[108:111], v[48:51], v[56:71]
    v_exp_f32 v121, v29
    v_cvt_pk_bf16_f32 v53, v118, v119
    v_exp_f32 v122, v30
    v_exp_f32 v123, v31
    s_waitcnt lgkmcnt(0)
    v_mfma_f32_32x32x16_bf16 v[16:31], v[100:103], v[88:91], 0
    v_cvt_pk_bf16_f32 v54, v120, v121
    v_exp_f32 v116, v32
    v_exp_f32 v117, v33
    buffer_load_dwordx4 v7, s[8:11], s18 offen offset:2048 lds
    v_cvt_pk_bf16_f32 v55, v122, v123
    v_exp_f32 v118, v34
    v_mfma_f32_32x32x16_bf16 v[204:219], v[156:159], v[168:171], v[204:219]
    buffer_load_dwordx4 v[156:159], v8, s[8:11], s28 offen offset:1024
    v_exp_f32 v119, v35
    v_cvt_pk_bf16_f32 v48, v116, v117
    v_exp_f32 v120, v36
    v_exp_f32 v121, v37
    v_cvt_pk_bf16_f32 v49, v118, v119
    v_mfma_f32_32x32x16_bf16 v[56:71], v[112:115], v[52:55], v[56:71]
    v_exp_f32 v122, v38
    v_exp_f32 v123, v39
    v_cvt_pk_bf16_f32 v50, v120, v121
    v_exp_f32 v116, v40
    v_mfma_f32_32x32x8_bf16 v[16:31], v[104:105], v[92:93], v[16:31]
    v_exp_f32 v117, v41
    v_cvt_pk_bf16_f32 v51, v122, v123
    v_exp_f32 v118, v42
    s_cmp_eq_u32 s21, 3
    s_cbranch_scc0 gated_mix__mha_block__glu_gated_geglu__prompt_kernel_p2_nd_9
    buffer_load_dwordx4 v7, s[8:11], s18 offen offset:3072 lds
gated_mix__mha_block__glu_gated_geglu__prompt_kernel_p2_nd_9:
    s_add_u32 s18, s18, 13312
    s_add_u32 s42, s42, 1
    s_add_u32 s41, s41, 13312
    s_cmp_eq_u32 s41, 53248
    s_cselect_b32 s41, 0, s41
    v_exp_f32 v119, v43
    v_cvt_pk_bf16_f32 v52, v116, v117
    v_mfma_f32_32x32x16_bf16 v[72:87], v[108:111], v[48:51], v[72:87]
    ds_read_b128 v[108:111], v10 offset:5120
    v_exp_f32 v120, v44
    v_exp_f32 v121, v45
    v_cvt_pk_bf16_f32 v53, v118, v119
    v_exp_f32 v122, v46
    v_exp_f32 v123, v47
    v_add_u32 v5, s40, v5
    v_add_u32 v6, s40, v6
    v_mfma_f32_32x32x16_bf16 v[32:47], v[100:103], v[94:97], 0
    ds_read_b128 v[100:103], v10 offset:1280
    ds_read_b64 v[106:107], v11 offset:1280
    v_cvt_pk_bf16_f32 v54, v120, v121
    v_exp_f32 v116, v16
    v_exp_f32 v117, v17
    v_cvt_pk_bf16_f32 v55, v122, v123
    v_mfma_f32_32x32x16_bf16 v[220:235], v[160:163], v[168:171], v[220:235]
    buffer_load_dwordx4 v[160:163], v8, s[8:11], s29 offen offset:1024
    v_exp_f32 v118, v18
    v_exp_f32 v119, v19
    v_cvt_pk_bf16_f32 v48, v116, v117
    v_exp_f32 v120, v20
    v_mfma_f32_32x32x16_bf16 v[72:87], v[112:115], v[52:55], v[72:87]
    ds_read_b128 v[112:115], v10 offset:6144
    v_exp_f32 v121, v21
    v_cvt_pk_bf16_f32 v49, v118, v119
    v_exp_f32 v122, v22
    v_exp_f32 v123, v23
    v_mfma_f32_32x32x8_bf16 v[32:47], v[104:105], v[98:99], v[32:47]
    v_cvt_pk_bf16_f32 v50, v120, v121
    v_exp_f32 v116, v24
    v_exp_f32 v117, v25
    v_cvt_pk_bf16_f32 v51, v122, v123
    v_mfma_f32_32x32x16_bf16 v[236:251], v[164:167], v[168:171], v[236:251]
    buffer_load_dwordx4 v[164:167], v8, s[8:11], s30 offen offset:1024
    buffer_load_dwordx4 v[168:171], v8, s[8:11], s31 offen offset:1024
    v_add_u32 v8, 2048, v8
    v_exp_f32 v118, v26
    v_exp_f32 v119, v27
    v_cvt_pk_bf16_f32 v52, v116, v117
    v_exp_f32 v120, v28
    s_waitcnt lgkmcnt(3)
    v_mfma_f32_32x32x16_bf16 v[56:71], v[108:111], v[48:51], v[56:71]
    v_exp_f32 v121, v29
    v_cvt_pk_bf16_f32 v53, v118, v119
    v_exp_f32 v122, v30
    v_exp_f32 v123, v31
    s_waitcnt lgkmcnt(0)
    v_mfma_f32_32x32x16_bf16 v[16:31], v[100:103], v[88:91], 0
    v_cvt_pk_bf16_f32 v54, v120, v121
    v_exp_f32 v116, v32
    v_exp_f32 v117, v33
    v_cvt_pk_bf16_f32 v55, v122, v123
    v_exp_f32 v118, v34
    s_cmp_eq_u32 s20, 2
    s_cbranch_scc0 gated_mix__mha_block__glu_gated_geglu__prompt_kernel_p2_nowo
    s_mov_b32 s26, s32
    s_mov_b32 s27, s33
    s_mov_b32 s28, s34
    s_mov_b32 s29, s35
    s_mov_b32 s30, s36
    s_add_u32 s31, s32, 2048
    v_mov_b32 v8, v4
gated_mix__mha_block__glu_gated_geglu__prompt_kernel_p2_nowo:
    s_waitcnt vmcnt(9)
    v_mfma_f32_32x32x16_bf16 v[172:187], v[124:127], v[144:147], v[172:187]
    buffer_load_dwordx4 v[124:127], v8, s[8:11], s26 offen offset:0
    v_exp_f32 v119, v35
    v_cvt_pk_bf16_f32 v48, v116, v117
    v_exp_f32 v120, v36
    v_exp_f32 v121, v37
    v_cvt_pk_bf16_f32 v49, v118, v119
    v_mfma_f32_32x32x16_bf16 v[56:71], v[112:115], v[52:55], v[56:71]
    v_exp_f32 v122, v38
    v_exp_f32 v123, v39
    v_cvt_pk_bf16_f32 v50, v120, v121
    v_exp_f32 v116, v40
    v_mfma_f32_32x32x8_bf16 v[16:31], v[106:107], v[92:93], v[16:31]
    v_exp_f32 v117, v41
    v_cvt_pk_bf16_f32 v51, v122, v123
    v_exp_f32 v118, v42
    v_exp_f32 v119, v43
    v_cvt_pk_bf16_f32 v52, v116, v117
    v_mfma_f32_32x32x16_bf16 v[72:87], v[108:111], v[48:51], v[72:87]
    ds_read_b128 v[108:111], v10 offset:7168
    v_exp_f32 v120, v44
    v_exp_f32 v121, v45
    v_cvt_pk_bf16_f32 v53, v118, v119
    v_exp_f32 v122, v46
    v_exp_f32 v123, v47
    v_mfma_f32_32x32x16_bf16 v[32:47], v[100:103], v[94:97], 0
    ds_read_b128 v[100:103], v10 offset:2560
    ds_read_b64 v[104:105], v11 offset:2560
    v_cvt_pk_bf16_f32 v54, v120, v121
    v_exp_f32 v116, v16
    v_exp_f32 v117, v17
    v_cvt_pk_bf16_f32 v55, v122, v123
    v_mfma_f32_32x32x16_bf16 v[188:203], v[128:131], v[144:147], v[188:203]
    buffer_load_dwordx4 v[128:131], v8, s[8:11], s27 offen offset:0
    v_exp_f32 v118, v18
    v_exp_f32 v119, v19
    v_cvt_pk_bf16_f32 v48, v116, v117
    v_exp_f32 v120, v20
    v_mfma_f32_32x32x16_bf16 v[72:87], v[112:115], v[52:55], v[72:87]
    ds_read_b128 v[112:115], v10 offset:8192
    v_exp_f32 v121, v21
    v_cvt_pk_bf16_f32 v49, v118, v119
    v_exp_f32 v122, v22
    v_exp_f32 v123, v23
    v_mfma_f32_32x32x8_bf16 v[32:47], v[106:107], v[98:99], v[32:47]
    v_cvt_pk_bf16_f32 v50, v120, v121
    v_exp_f32 v116, v24
    v_exp_f32 v117, v25
    v_cvt_pk_bf16_f32 v51, v122, v123
    v_mfma_f32_32x32x16_bf16 v[204:219], v[132:135], v[144:147], v[204:219]
    buffer_load_dwordx4 v[132:135], v8, s[8:11], s28 offen offset:0
    v_exp_f32 v118, v26
    v_exp_f32 v119, v27
    v_cvt_pk_bf16_f32 v52, v116, v117
    v_exp_f32 v120, v28
    s_waitcnt lgkmcnt(3)
    v_mfma_f32_32x32x16_bf16 v[56:71], v[108:111], v[48:51], v[56:71]
    v_exp_f32 v121, v29
    v_cvt_pk_bf16_f32 v53, v118, v119
    v_exp_f32 v122, v30
    v_exp_f32 v123, v31
    s_waitcnt lgkmcnt(0)
    v_mfma_f32_32x32x16_bf16 v[16:31], v[100:103], v[88:91], 0
    v_cvt_pk_bf16_f32 v54, v120, v121
    v_exp_f32 v116, v32
    v_exp_f32 v117, v33
    v_cvt_pk_bf16_f32 v55, v122, v123
    v_exp_f32 v118, v34
    v_mfma_f32_32x32x16_bf16 v[220:235], v[136:139], v[144:147], v[220:235]
    buffer_load_dwordx4 v[136:139], v8, s[8:11], s29 offen offset:0
    v_exp_f32 v119, v35
    v_cvt_pk_bf16_f32 v48, v116, v117
    v_exp_f32 v120, v36
    v_exp_f32 v121, v37
    v_cvt_pk_bf16_f32 v49, v118, v119
    v_mfma_f32_32x32x16_bf16 v[56:71], v[112:115], v[52:55], v[56:71]
    v_exp_f32 v122, v38
    v_exp_f32 v123, v39
    v_cvt_pk_bf16_f32 v50, v120, v121
    v_exp_f32 v116, v40
    v_mfma_f32_32x32x8_bf16 v[16:31], v[104:105], v[92:93], v[16:31]
    v_exp_f32 v117, v41
    v_cvt_pk_bf16_f32 v51, v122, v123
    v_exp_f32 v118, v42
    v_exp_f32 v119, v43
    v_cvt_pk_bf16_f32 v52, v116, v117
    v_mfma_f32_32x32x16_bf16 v[72:87], v[108:111], v[48:51], v[72:87]
    ds_read_b128 v[108:111], v10 offset:9216
    v_exp_f32 v120, v44
    v_exp_f32 v121, v45
    v_cvt_pk_bf16_f32 v53, v118, v119
    v_exp_f32 v122, v46
    v_exp_f32 v123, v47
    v_mfma_f32_32x32x16_bf16 v[32:47], v[100:103], v[94:97], 0
    ds_read_b128 v[100:103], v10 offset:3840
    ds_read_b64 v[106:107], v11 offset:3840
    v_cvt_pk_bf16_f32 v54, v120, v121
    v_exp_f32 v116, v16
    v_exp_f32 v117, v17
    v_cvt_pk_bf16_f32 v55, v122, v123
    v_mfma_f32_32x32x16_bf16 v[236:251], v[140:143], v[144:147], v[236:251]
    buffer_load_dwordx4 v[140:143], v8, s[8:11], s30 offen offset:0
    buffer_load_dwordx4 v[144:147], v8, s[8:11], s31 offen offset:0
    v_exp_f32 v118, v18
    v_exp_f32 v119, v19
    v_cvt_pk_bf16_f32 v48, v116, v117
    v_exp_f32 v120, v20
    v_mfma_f32_32x32x16_bf16 v[72:87], v[112:115], v[52:55], v[72:87]
    ds_read_b128 v[112:115], v10 offset:10240
    v_exp_f32 v121, v21
    v_cvt_pk_bf16_f32 v49, v118, v119
    v_exp_f32 v122, v22
    v_exp_f32 v123, v23
    v_mfma_f32_32x32x8_bf16 v[32:47], v[104:105], v[98:99], v[32:47]
    v_cvt_pk_bf16_f32 v50, v120, v121
    v_exp_f32 v116, v24
    v_exp_f32 v117, v25
    v_cvt_pk_bf16_f32 v51, v122, v123
    s_waitcnt vmcnt(6)
    v_mfma_f32_32x32x16_bf16 v[172:187], v[148:151], v[168:171], v[172:187]
    buffer_load_dwordx4 v[148:151], v8, s[8:11], s26 offen offset:1024
    v_exp_f32 v118, v26
    v_exp_f32 v119, v27
    v_cvt_pk_bf16_f32 v52, v116, v117
    v_exp_f32 v120, v28
    s_waitcnt lgkmcnt(3)
    v_mfma_f32_32x32x16_bf16 v[56:71], v[108:111], v[48:51], v[56:71]
    v_exp_f32 v121, v29
    v_cvt_pk_bf16_f32 v53, v118, v119
    v_exp_f32 v122, v30
    v_exp_f32 v123, v31
    s_waitcnt lgkmcnt(0)
    v_mfma_f32_32x32x16_bf16 v[16:31], v[100:103], v[88:91], 0
    v_cvt_pk_bf16_f32 v54, v120, v121
    v_exp_f32 v116, v32
    v_exp_f32 v117, v33
    v_cvt_pk_bf16_f32 v55, v122, v123
    v_exp_f32 v118, v34
    v_mfma_f32_32x32x16_bf16 v[188:203], v[152:155], v[168:171], v[188:203]
    buffer_load_dwordx4 v[152:155], v8, s[8:11], s27 offen offset:1024
    v_exp_f32 v119, v35
    v_cvt_pk_bf16_f32 v48, v116, v117
    v_exp_f32 v120, v36
    v_exp_f32 v121, v37
    v_cvt_pk_bf16_f32 v49, v118, v119
    v_mfma_f32_32x32x16_bf16 v[56:71], v[112:115], v[52:55], v[56:71]
    v_exp_f32 v122, v38
    v_exp_f32 v123, v39
    v_cvt_pk_bf16_f32 v50, v120, v121
    v_exp_f32 v116, v40
    v_mfma_f32_32x32x8_bf16 v[16:31], v[106:107], v[92:93], v[16:31]
    v_exp_f32 v117, v41
    v_cvt_pk_bf16_f32 v51, v122, v123
    v_exp_f32 v118, v42
    v_exp_f32 v119, v43
    v_cvt_pk_bf16_f32 v52, v116, v117
    v_mfma_f32_32x32x16_bf16 v[72:87], v[108:111], v[48:51], v[72:87]
    ds_read_b128 v[108:111], v10 offset:11264
    v_exp_f32 v120, v44
    v_exp_f32 v121, v45
    v_cvt_pk_bf16_f32 v53, v118, v119
    v_exp_f32 v122, v46
    v_exp_f32 v123, v47
    s_waitcnt vmcnt(25)
    s_barrier
    v_mfma_f32_32x32x16_bf16 v[32:47], v[100:103], v[94:97], 0
    ds_read_b128 v[100:103], v5 offset:0
    ds_read_b64 v[104:105], v6 offset:0
    v_cvt_pk_bf16_f32 v54, v120, v121
    v_exp_f32 v116, v16
    v_exp_f32 v117, v17
    s_cmp_ge_u32 s42, 8
    s_cselect_b32 s13, 0x7fff0000, 0
    s_add_u32 m0, s19, s41
    v_or_b32 v7, s13, v4
    buffer_load_dwordx4 v7, s[8:11], s18 offen offset:0 lds
    v_cvt_pk_bf16_f32 v55, v122, v123
    v_mfma_f32_32x32x16_bf16 v[204:219], v[156:159], v[168:171], v[204:219]
    buffer_load_dwordx4 v[156:159], v8, s[8:11], s28 offen offset:1024
    v_exp_f32 v118, v18
    v_exp_f32 v119, v19
    v_cvt_pk_bf16_f32 v48, v116, v117
    v_exp_f32 v120, v20
    v_mfma_f32_32x32x16_bf16 v[72:87], v[112:115], v[52:55], v[72:87]
    ds_read_b128 v[112:115], v10 offset:12288
    v_exp_f32 v121, v21
    v_cvt_pk_bf16_f32 v49, v118, v119
    v_exp_f32 v122, v22
    v_exp_f32 v123, v23
    v_mfma_f32_32x32x8_bf16 v[32:47], v[106:107], v[98:99], v[32:47]
    v_cvt_pk_bf16_f32 v50, v120, v121
    v_exp_f32 v116, v24
    v_exp_f32 v117, v25
    v_cvt_pk_bf16_f32 v51, v122, v123
    v_mfma_f32_32x32x16_bf16 v[220:235], v[160:163], v[168:171], v[220:235]
    buffer_load_dwordx4 v[160:163], v8, s[8:11], s29 offen offset:1024
    v_exp_f32 v118, v26
    buffer_load_dwordx4 v7, s[8:11], s18 offen offset:1024 lds
    v_exp_f32 v119, v27
    v_cvt_pk_bf16_f32 v52, v116, v117
    v_exp_f32 v120, v28
    s_waitcnt lgkmcnt(3)
    v_mfma_f32_32x32x16_bf16 v[56:71], v[108:111], v[48:51], v[56:71]
    v_exp_f32 v121, v29
    v_cvt_pk_bf16_f32 v53, v118, v119
    v_exp_f32 v122, v30
    v_exp_f32 v123, v31
    v_add_u32 v10, s40, v10
    v_add_u32 v11, s40, v11
    s_waitcnt lgkmcnt(0)
    v_mfma_f32_32x32x16_bf16 v[16:31], v[100:103], v[88:91], 0
    v_cvt_pk_bf16_f32 v54, v120, v121
    v_exp_f32 v116, v32
    v_exp_f32 v117, v33
    buffer_load_dwordx4 v7, s[8:11], s18 offen offset:2048 lds
    v_cvt_pk_bf16_f32 v55, v122, v123
    v_exp_f32 v118, v34
    v_mfma_f32_32x32x16_bf16 v[236:251], v[164:167], v[168:171], v[236:251]
    buffer_load_dwordx4 v[164:167], v8, s[8:11], s30 offen offset:1024
    buffer_load_dwordx4 v[168:171], v8, s[8:11], s31 offen offset:1024
    v_add_u32 v8, 2048, v8
    v_exp_f32 v119, v35
    v_cvt_pk_bf16_f32 v48, v116, v117
    v_exp_f32 v120, v36
    v_exp_f32 v121, v37
    v_cvt_pk_bf16_f32 v49, v118, v119
    v_mfma_f32_32x32x16_bf16 v[56:71], v[112:115], v[52:55], v[56:71]
    v_exp_f32 v122, v38
    v_exp_f32 v123, v39
    v_cvt_pk_bf16_f32 v50, v120, v121
    v_exp_f32 v116, v40
    v_mfma_f32_32x32x8_bf16 v[16:31], v[104:105], v[92:93], v[16:31]
    v_exp_f32 v117, v41
    v_cvt_pk_bf16_f32 v51, v122, v123
    v_exp_f32 v118, v42
    s_cmp_eq_u32 s21, 3
    s_cbranch_scc0 gated_mix__mha_block__glu_gated_geglu__prompt_kernel_p2_nd_10
    buffer_load_dwordx4 v7, s[8:11], s18 offen offset:3072 lds
gated_mix__mha_block__glu_gated_geglu__prompt_kernel_p2_nd_10:
    s_add_u32 s18, s18, 13312
    s_add_u32 s42, s42, 1
    s_add_u32 s41, s41, 13312
    s_cmp_eq_u32 s41, 53248
    s_cselect_b32 s41, 0, s41
    v_exp_f32 v119, v43
    v_cvt_pk_bf16_f32 v52, v116, v117
    v_mfma_f32_32x32x16_bf16 v[72:87], v[108:111], v[48:51], v[72:87]
    ds_read_b128 v[108:111], v5 offset:5120
    v_exp_f32 v120, v44
    v_exp_f32 v121, v45
    v_cvt_pk_bf16_f32 v53, v118, v119
    v_exp_f32 v122, v46
    v_exp_f32 v123, v47
    s_sub_u32 s40, 0, s40
    s_add_u32 s20, s20, 1
    s_cmp_lt_u32 s20, 3
    s_cbranch_scc1 gated_mix__mha_block__glu_gated_geglu__prompt_kernel_p2_aloop
    s_setprio 0
    v_cvt_pk_bf16_f32 v54, v120, v121
    v_cvt_pk_bf16_f32 v55, v122, v123
    s_waitcnt lgkmcnt(0)
    s_nop 1
    v_mfma_f32_32x32x16_bf16 v[72:87], v[112:115], v[52:55], v[72:87]
    s_mul_i32 s13, s12, 3072
    s_add_u32 s13, s13, 106496
    v_add_u32 v11, s13, v4
    s_xor_b32 s14, s12, 4
    s_mul_i32 s14, s14, 3072
    s_add_u32 s14, s14, 106496
    v_add_u32 v12, s14, v4
    s_nop 7
    s_cmp_eq_u32 s22, 0
    s_cbranch_scc0 gated_mix__mha_block__glu_gated_geglu__prompt_kernel_p2_cmb1
    s_nop 3
    ds_write_b128 v11, v[72:75] offset:0
    ds_write_b128 v11, v[76:79] offset:1024
    ds_write_b128 v11, v[80:83] offset:2048
    s_branch gated_mix__mha_block__glu_gated_geglu__prompt_kernel_p2_cmb2
gated_mix__mha_block__glu_gated_geglu__prompt_kernel_p2_cmb1:
    ds_write_b128 v11, v[56:59] offset:0
    ds_write_b128 v11, v[60:63] offset:1024
    ds_write_b128 v11, v[64:67] offset:2048
    s_nop 1
    v_mov_b32 v56, v72
    v_mov_b32 v57, v73
    v_mov_b32 v58, v74
    v_mov_b32 v59, v75
    v_mov_b32 v60, v76
    v_mov_b32 v61, v77
    v_mov_b32 v62, v78
    v_mov_b32 v63, v79
    v_mov_b32 v64, v80
    v_mov_b32 v65, v81
    v_mov_b32 v66, v82
    v_mov_b32 v67, v83
gated_mix__mha_block__glu_gated_geglu__prompt_kernel_p2_cmb2:
    s_waitcnt lgkmcnt(0)
    s_barrier
    ds_read_b128 v[72:75], v12 offset:0
    ds_read_b128 v[76:79], v12 offset:1024
    ds_read_b128 v[80:83], v12 offset:2048
    s_waitcnt lgkmcnt(0)
    v_add_f32 v56, v56, v72
    v_add_f32 v57, v57, v73
    v_add_f32 v58, v58, v74
    v_add_f32 v59, v59, v75
    v_add_f32 v60, v60, v76
    v_add_f32 v61, v61, v77
    v_add_f32 v62, v62, v78
    v_add_f32 v63, v63, v79
    v_add_f32 v64, v64, v80
    v_add_f32 v65, v65, v81
    v_add_f32 v66, v66, v82
    v_add_f32 v67, v67, v83
    v_mov_b32 v72, v64
    v_mov_b32 v73, v64
    s_nop 1
    v_permlane32_swap_b32 v72, v73
    s_nop 1
    v_mov_b32 v74, 0
    v_fma_f32 v74, v56, 0, v74
    v_fma_f32 v74, v57, 0, v74
    v_fma_f32 v74, v58, 0, v74
    v_fma_f32 v74, v59, 0, v74
    v_fma_f32 v74, v60, 0, v74
    v_fma_f32 v74, v61, 0, v74
    v_fma_f32 v74, v62, 0, v74
    v_fma_f32 v74, v63, 0, v74
    v_fma_f32 v74, v64, 0, v74
    v_fma_f32 v74, v65, 0, v74
    v_fma_f32 v74, v66, 0, v74
    v_fma_f32 v74, v67, 0, v74
    v_cmp_o_f32 vcc, v74, v74
    v_cmp_le_f32 s[50:51], s52, v73
    v_cmp_ge_f32 s[54:55], s53, v73
    s_nop 3
    s_and_b64 vcc, vcc, s[50:51]
    s_and_b64 vcc, vcc, s[54:55]
    s_cmp_eq_u64 vcc, -1
    s_cbranch_scc1 gated_mix__mha_block__glu_gated_geglu__prompt_kernel_p2_fastok
    s_cmp_eq_u32 s22, 0
    s_cbranch_scc0 gated_mix__mha_block__glu_gated_geglu__prompt_kernel_p2_fb_b
    v_mov_b32 v32, v88
    v_mov_b32 v33, v89
    v_mov_b32 v34, v90
    v_mov_b32 v35, v91
    v_mov_b32 v36, v92
    v_mov_b32 v37, v93
    s_branch gated_mix__mha_block__glu_gated_geglu__prompt_kernel_p2_fb_go
gated_mix__mha_block__glu_gated_geglu__prompt_kernel_p2_fb_b:
    v_mov_b32 v32, v94
    v_mov_b32 v33, v95
    v_mov_b32 v34, v96
    v_mov_b32 v35, v97
    v_mov_b32 v36, v98
    v_mov_b32 v37, v99
gated_mix__mha_block__glu_gated_geglu__prompt_kernel_p2_fb_go:
    v_mov_b32 v56, 0
    v_mov_b32 v57, 0
    v_mov_b32 v58, 0
    v_mov_b32 v59, 0
    v_mov_b32 v60, 0
    v_mov_b32 v61, 0
    v_mov_b32 v62, 0
    v_mov_b32 v63, 0
    v_mov_b32 v64, 0
    v_mov_b32 v65, 0
    v_mov_b32 v66, 0
    v_mov_b32 v67, 0
    v_mov_b32 v68, 0
    v_mov_b32 v69, 0
    v_mov_b32 v70, 0
    v_mov_b32 v71, 0
    v_mov_b32 v116, 0xff7fffff
    v_and_b32 v3, 31, v2
    v_lshlrev_b32 v14, 3, v3
    v_add_u32 v14, 1024, v14
    s_mul_i32 s56, s16, 212992
    s_add_u32 s56, s56, 2621440
    s_mov_b32 s57, 0
gated_mix__mha_block__glu_gated_geglu__prompt_kernel_p2_fb_loop:
    s_lshr_b32 s58, s57, 2
    s_mul_i32 s58, s58, 13312
    s_add_u32 s58, s58, s56
    s_and_b32 s59, s57, 3
    s_mul_i32 s60, s59, 1280
    s_add_u32 s60, s60, s58
    s_lshl_b32 s59, s59, 11
    s_add_u32 s59, s59, s58
    s_add_u32 s59, s59, 5120
    buffer_load_dwordx4 v[100:103], v4, s[8:11], s60 offen
    buffer_load_dwordx2 v[104:105], v14, s[8:11], s60 offen
    buffer_load_dwordx4 v[108:111], v4, s[8:11], s59 offen
    buffer_load_dwordx4 v[112:115], v4, s[8:11], s59 offen offset:1024
    s_waitcnt vmcnt(0)
    v_mfma_f32_32x32x16_bf16 v[16:31], v[100:103], v[32:35], 0
    s_nop 15
    v_mfma_f32_32x32x8_bf16 v[16:31], v[104:105], v[36:37], v[16:31]
    s_nop 15
    v_max3_f32 v118, v16, v17, v18
    v_max3_f32 v118, v118, v19, v20
    v_max3_f32 v118, v118, v21, v22
    v_max3_f32 v118, v118, v23, v24
    v_max3_f32 v118, v118, v25, v26
    v_max3_f32 v118, v118, v27, v28
    v_max3_f32 v118, v118, v29, v30
    v_max_f32 v118, v118, v31
    v_mov_b32 v119, v118
    s_nop 1
    v_permlane32_swap_b32 v118, v119
    s_nop 1
    v_max3_f32 v118, v118, v119, v116
    v_sub_f32 v117, v116, v118
    v_exp_f32 v117, v117
    v_mov_b32 v116, v118
    v_sub_f32 v16, v16, v116
    v_sub_f32 v17, v17, v116
    v_sub_f32 v18, v18, v116
    v_sub_f32 v19, v19, v116
    v_sub_f32 v20, v20, v116
    v_sub_f32 v21, v21, v116
    v_sub_f32 v22, v22, v116
    v_sub_f32 v23, v23, v116
    v_sub_f32 v24, v24, v116
    v_sub_f32 v25, v25, v116
    v_sub_f32 v26, v26, v116
    v_sub_f32 v27, v27, v116
    v_sub_f32 v28, v28, v116
    v_sub_f32 v29, v29, v116
    v_sub_f32 v30, v30, v116
    v_sub_f32 v31, v31, v116
    v_exp_f32 v16, v16
    v_exp_f32 v17, v17
    v_exp_f32 v18, v18
    v_exp_f32 v19, v19
    v_exp_f32 v20, v20
    v_exp_f32 v21, v21
    v_exp_f32 v22, v22
    v_exp_f32 v23, v23
    v_exp_f32 v24, v24
    v_exp_f32 v25, v25
    v_exp_f32 v26, v26
    v_exp_f32 v27, v27
    v_exp_f32 v28, v28
    v_exp_f32 v29, v29
    v_exp_f32 v30, v30
    v_exp_f32 v31, v31
    s_nop 0
    v_cvt_pk_bf16_f32 v48, v16, v17
    v_cvt_pk_bf16_f32 v49, v18, v19
    v_cvt_pk_bf16_f32 v50, v20, v21
    v_cvt_pk_bf16_f32 v51, v22, v23
    v_cvt_pk_bf16_f32 v52, v24, v25
    v_cvt_pk_bf16_f32 v53, v26, v27
    v_cvt_pk_bf16_f32 v54, v28, v29
    v_cvt_pk_bf16_f32 v55, v30, v31
    v_mul_f32 v56, v56, v117
    v_mul_f32 v57, v57, v117
    v_mul_f32 v58, v58, v117
    v_mul_f32 v59, v59, v117
    v_mul_f32 v60, v60, v117
    v_mul_f32 v61, v61, v117
    v_mul_f32 v62, v62, v117
    v_mul_f32 v63, v63, v117
    v_mul_f32 v64, v64, v117
    v_mul_f32 v65, v65, v117
    v_mul_f32 v66, v66, v117
    v_mul_f32 v67, v67, v117
    v_mul_f32 v68, v68, v117
    v_mul_f32 v69, v69, v117
    v_mul_f32 v70, v70, v117
    v_mul_f32 v71, v71, v117
    s_nop 1
    v_mfma_f32_32x32x16_bf16 v[56:71], v[108:111], v[48:51], v[56:71]
    v_mfma_f32_32x32x16_bf16 v[56:71], v[112:115], v[52:55], v[56:71]
    s_nop 15
    s_add_u32 s57, s57, 1
    s_cmp_lt_u32 s57, 64
    s_cbranch_scc1 gated_mix__mha_block__glu_gated_geglu__prompt_kernel_p2_fb_loop
    v_mov_b32 v72, v64
    v_mov_b32 v73, v64
    s_nop 1
    v_permlane32_swap_b32 v72, v73
    s_nop 1
gated_mix__mha_block__glu_gated_geglu__prompt_kernel_p2_fastok:
    v_rcp_f32 v73, v73
    s_nop 0
    v_mul_f32 v73, v73, v252
    v_mul_f32 v56, v56, v73
    v_mul_f32 v57, v57, v73
    v_mul_f32 v58, v58, v73
    v_mul_f32 v59, v59, v73
    v_mul_f32 v60, v60, v73
    v_mul_f32 v61, v61, v73
    v_mul_f32 v62, v62, v73
    v_mul_f32 v63, v63, v73
    v_mul_f32 v64, v64, v73
    v_mul_f32 v65, v65, v73
    v_mul_f32 v66, v66, v73
    v_mul_f32 v67, v67, v73
    v_cvt_pk_bf16_f32 v76, v56, v57
    v_cvt_pk_bf16_f32 v77, v58, v59
    v_cvt_pk_bf16_f32 v78, v60, v61
    v_cvt_pk_bf16_f32 v79, v62, v63
    v_cvt_pk_bf16_f32 v80, v64, v65
    v_cvt_pk_bf16_f32 v81, v66, v67
    s_add_u32 s13, s17, s22
    s_mul_i32 s13, s13, 40960
    s_add_u32 s13, s13, 18874368
    s_lshl_b32 s14, s16, 10
    s_add_u32 s14, s14, s13
    buffer_store_dwordx4 v[76:79], v4, s[8:11], s14 offen sc1
    s_lshr_b32 s14, s16, 2
    s_add_u32 s14, s14, 32
    s_lshl_b32 s14, s14, 10
    s_add_u32 s13, s13, s14
    s_bfe_u32 s14, s16, 0x10001
    s_lshl_b32 s14, s14, 9
    s_add_u32 s13, s13, s14
    s_and_b32 s14, s16, 1
    s_lshl_b32 s14, s14, 3
    s_add_u32 s13, s13, s14
    s_mov_b32 exec_hi, 0
    buffer_store_dwordx2 v[80:81], v4, s[8:11], s13 offen sc1
    s_mov_b64 exec, -1
    s_mul_i32 s37, s23, 40960
    s_mul_i32 s14, s12, 5120
    s_add_u32 s37, s37, s14
    s_add_u32 s37, s37, 18874368
    v_add_u32 v15, 4096, v4
    v_sub_f32 v253, 1.0, v253
    buffer_load_dwordx4 v[16:19], v4, s[8:11], s33 offen offset:2048
    v_mul_f32 v172, v172, v253
    v_mul_f32 v173, v173, v253
    v_mul_f32 v174, v174, v253
    v_mul_f32 v175, v175, v253
    v_mul_f32 v176, v176, v253
    v_mul_f32 v177, v177, v253
    v_mul_f32 v178, v178, v253
    buffer_load_dwordx4 v[20:23], v4, s[8:11], s34 offen offset:2048
    v_mul_f32 v179, v179, v253
    v_mul_f32 v180, v180, v253
    v_mul_f32 v181, v181, v253
    v_mul_f32 v182, v182, v253
    v_mul_f32 v183, v183, v253
    v_mul_f32 v184, v184, v253
    v_mul_f32 v185, v185, v253
    buffer_load_dwordx4 v[24:27], v4, s[8:11], s35 offen offset:2048
    v_mul_f32 v186, v186, v253
    v_mul_f32 v187, v187, v253
    v_mul_f32 v188, v188, v253
    v_mul_f32 v189, v189, v253
    v_mul_f32 v190, v190, v253
    v_mul_f32 v191, v191, v253
    v_mul_f32 v192, v192, v253
    buffer_load_dwordx4 v[28:31], v4, s[8:11], s36 offen offset:2048
    v_mul_f32 v193, v193, v253
    v_mul_f32 v194, v194, v253
    v_mul_f32 v195, v195, v253
    v_mul_f32 v196, v196, v253
    v_mul_f32 v197, v197, v253
    v_mul_f32 v198, v198, v253
    v_mul_f32 v199, v199, v253
    buffer_load_dwordx4 v[32:35], v4, s[8:11], s33 offen offset:3072
    v_mul_f32 v200, v200, v253
    v_mul_f32 v201, v201, v253
    v_mul_f32 v202, v202, v253
    v_mul_f32 v203, v203, v253
    v_mul_f32 v204, v204, v253
    v_mul_f32 v205, v205, v253
    v_mul_f32 v206, v206, v253
    buffer_load_dwordx4 v[36:39], v4, s[8:11], s34 offen offset:3072
    v_mul_f32 v207, v207, v253
    v_mul_f32 v208, v208, v253
    v_mul_f32 v209, v209, v253
    v_mul_f32 v210, v210, v253
    v_mul_f32 v211, v211, v253
    v_mul_f32 v212, v212, v253
    v_mul_f32 v213, v213, v253
    buffer_load_dwordx4 v[40:43], v4, s[8:11], s35 offen offset:3072
    v_mul_f32 v214, v214, v253
    v_mul_f32 v215, v215, v253
    v_mul_f32 v216, v216, v253
    v_mul_f32 v217, v217, v253
    v_mul_f32 v218, v218, v253
    v_mul_f32 v219, v219, v253
    v_mul_f32 v220, v220, v253
    buffer_load_dwordx4 v[44:47], v4, s[8:11], s36 offen offset:3072
    v_mul_f32 v221, v221, v253
    v_mul_f32 v222, v222, v253
    v_mul_f32 v223, v223, v253
    v_mul_f32 v224, v224, v253
    v_mul_f32 v225, v225, v253
    v_mul_f32 v226, v226, v253
    v_mul_f32 v227, v227, v253
    buffer_load_dwordx4 v[48:51], v15, s[8:11], s32 offen
    v_mul_f32 v228, v228, v253
    v_mul_f32 v229, v229, v253
    v_mul_f32 v230, v230, v253
    v_mul_f32 v231, v231, v253
    v_mul_f32 v232, v232, v253
    v_mul_f32 v233, v233, v253
    v_mul_f32 v234, v234, v253
    buffer_load_dwordx4 v[52:55], v15, s[8:11], s33 offen
    v_mul_f32 v235, v235, v253
    v_mul_f32 v236, v236, v253
    v_mul_f32 v237, v237, v253
    v_mul_f32 v238, v238, v253
    v_mul_f32 v239, v239, v253
    v_mul_f32 v240, v240, v253
    v_mul_f32 v241, v241, v253
    buffer_load_dwordx4 v[88:91], v15, s[8:11], s34 offen
    v_mul_f32 v242, v242, v253
    v_mul_f32 v243, v243, v253
    v_mul_f32 v244, v244, v253
    v_mul_f32 v245, v245, v253
    v_mul_f32 v246, v246, v253
    v_mul_f32 v247, v247, v253
    v_mul_f32 v248, v248, v253
    buffer_load_dwordx4 v[92:95], v15, s[8:11], s35 offen
    v_mul_f32 v249, v249, v253
    v_mul_f32 v250, v250, v253
    v_mul_f32 v251, v251, v253
    buffer_load_dwordx4 v[96:99], v15, s[8:11], s36 offen
    s_mov_b32 s14, 0
gated_mix__mha_block__glu_gated_geglu__prompt_kernel_p2_poll:
    buffer_load_dwordx4 v[100:103], v4, s[8:11], s37 offen offset:0 sc1
    buffer_load_dwordx4 v[104:107], v4, s[8:11], s37 offen offset:1024 sc1
    buffer_load_dwordx4 v[108:111], v4, s[8:11], s37 offen offset:2048 sc1
    buffer_load_dwordx4 v[112:115], v4, s[8:11], s37 offen offset:3072 sc1
    buffer_load_dwordx4 v[116:119], v15, s[8:11], s37 offen sc1
    s_waitcnt vmcnt(0)
    v_max3_u32 v14, v100, v101, v102
    v_max3_u32 v14, v14, v103, v104
    v_max3_u32 v14, v14, v105, v106
    v_max3_u32 v14, v14, v107, v108
    v_max3_u32 v14, v14, v109, v110
    v_max3_u32 v14, v14, v111, v112
    v_max3_u32 v14, v14, v113, v114
    v_max3_u32 v14, v14, v115, v116
    v_max3_u32 v14, v14, v117, v118
    v_max_u32 v14, v14, v119
    v_cmp_eq_u32 vcc, -1, v14
    s_add_u32 s14, s14, 1
    s_nop 1
    s_cbranch_vccz gated_mix__mha_block__glu_gated_geglu__prompt_kernel_p2_polldone
    s_cmp_lt_u32 s14, 0x40000
    s_cbranch_scc1 gated_mix__mha_block__glu_gated_geglu__prompt_kernel_p2_poll
gated_mix__mha_block__glu_gated_geglu__prompt_kernel_p2_polldone:
    v_mfma_f32_32x32x16_bf16 v[172:187], v[124:127], v[100:103], v[172:187]
    v_mfma_f32_32x32x16_bf16 v[188:203], v[128:131], v[100:103], v[188:203]
    v_mfma_f32_32x32x16_bf16 v[204:219], v[132:135], v[100:103], v[204:219]
    v_mfma_f32_32x32x16_bf16 v[220:235], v[136:139], v[100:103], v[220:235]
    v_mfma_f32_32x32x16_bf16 v[236:251], v[140:143], v[100:103], v[236:251]
    v_mfma_f32_32x32x16_bf16 v[172:187], v[148:151], v[104:107], v[172:187]
    v_mfma_f32_32x32x16_bf16 v[188:203], v[152:155], v[104:107], v[188:203]
    v_mfma_f32_32x32x16_bf16 v[204:219], v[156:159], v[104:107], v[204:219]
    v_mfma_f32_32x32x16_bf16 v[220:235], v[160:163], v[104:107], v[220:235]
    v_mfma_f32_32x32x16_bf16 v[236:251], v[164:167], v[104:107], v[236:251]
    v_mfma_f32_32x32x16_bf16 v[172:187], v[144:147], v[108:111], v[172:187]
    v_mfma_f32_32x32x16_bf16 v[188:203], v[16:19], v[108:111], v[188:203]
    v_mfma_f32_32x32x16_bf16 v[204:219], v[20:23], v[108:111], v[204:219]
    v_mfma_f32_32x32x16_bf16 v[220:235], v[24:27], v[108:111], v[220:235]
    v_mfma_f32_32x32x16_bf16 v[236:251], v[28:31], v[108:111], v[236:251]
    v_mfma_f32_32x32x16_bf16 v[172:187], v[168:171], v[112:115], v[172:187]
    v_mfma_f32_32x32x16_bf16 v[188:203], v[32:35], v[112:115], v[188:203]
    v_mfma_f32_32x32x16_bf16 v[204:219], v[36:39], v[112:115], v[204:219]
    v_mfma_f32_32x32x16_bf16 v[220:235], v[40:43], v[112:115], v[220:235]
    v_mfma_f32_32x32x16_bf16 v[236:251], v[44:47], v[112:115], v[236:251]
    v_mfma_f32_32x32x16_bf16 v[172:187], v[48:51], v[116:119], v[172:187]
    v_mfma_f32_32x32x16_bf16 v[188:203], v[52:55], v[116:119], v[188:203]
    v_mfma_f32_32x32x16_bf16 v[204:219], v[88:91], v[116:119], v[204:219]
    v_mfma_f32_32x32x16_bf16 v[220:235], v[92:95], v[116:119], v[220:235]
    v_mfma_f32_32x32x16_bf16 v[236:251], v[96:99], v[116:119], v[236:251]
    s_nop 15
    v_cvt_pk_bf16_f32 v56, v172, v173
    v_cvt_pk_bf16_f32 v57, v174, v175
    v_cvt_pk_bf16_f32 v60, v176, v177
    v_cvt_pk_bf16_f32 v61, v178, v179
    v_cvt_pk_bf16_f32 v64, v180, v181
    v_cvt_pk_bf16_f32 v65, v182, v183
    v_cvt_pk_bf16_f32 v68, v184, v185
    v_cvt_pk_bf16_f32 v69, v186, v187
    v_cvt_pk_bf16_f32 v72, v188, v189
    v_cvt_pk_bf16_f32 v73, v190, v191
    v_cvt_pk_bf16_f32 v76, v192, v193
    v_cvt_pk_bf16_f32 v77, v194, v195
    v_cvt_pk_bf16_f32 v80, v196, v197
    v_cvt_pk_bf16_f32 v81, v198, v199
    v_cvt_pk_bf16_f32 v84, v200, v201
    v_cvt_pk_bf16_f32 v85, v202, v203
    v_cvt_pk_bf16_f32 v58, v204, v205
    v_cvt_pk_bf16_f32 v59, v206, v207
    v_cvt_pk_bf16_f32 v62, v208, v209
    v_cvt_pk_bf16_f32 v63, v210, v211
    v_cvt_pk_bf16_f32 v66, v212, v213
    v_cvt_pk_bf16_f32 v67, v214, v215
    v_cvt_pk_bf16_f32 v70, v216, v217
    v_cvt_pk_bf16_f32 v71, v218, v219
    v_cvt_pk_bf16_f32 v74, v220, v221
    v_cvt_pk_bf16_f32 v75, v222, v223
    v_cvt_pk_bf16_f32 v78, v224, v225
    v_cvt_pk_bf16_f32 v79, v226, v227
    v_cvt_pk_bf16_f32 v82, v228, v229
    v_cvt_pk_bf16_f32 v83, v230, v231
    v_cvt_pk_bf16_f32 v86, v232, v233
    v_cvt_pk_bf16_f32 v87, v234, v235
    v_cvt_pk_bf16_f32 v48, v236, v237
    v_cvt_pk_bf16_f32 v49, v238, v239
    v_cvt_pk_bf16_f32 v50, v240, v241
    v_cvt_pk_bf16_f32 v51, v242, v243
    v_cvt_pk_bf16_f32 v52, v244, v245
    v_cvt_pk_bf16_f32 v53, v246, v247
    v_cvt_pk_bf16_f32 v54, v248, v249
    v_cvt_pk_bf16_f32 v55, v250, v251
    s_lshl_b32 s13, s12, 13
    v_add_u32 v9, s13, v4
    s_lshl_b32 s13, s12, 11
    s_add_u32 s13, s13, 65536
    v_lshlrev_b32 v13, 3, v2
    v_add_u32 v14, s13, v13
    ds_write_b128 v9, v[56:59] offset:0
    ds_write_b128 v9, v[60:63] offset:1024
    ds_write_b128 v9, v[64:67] offset:2048
    ds_write_b128 v9, v[68:71] offset:3072
    ds_write_b128 v9, v[72:75] offset:4096
    ds_write_b128 v9, v[76:79] offset:5120
    ds_write_b128 v9, v[80:83] offset:6144
    ds_write_b128 v9, v[84:87] offset:7168
    ds_write_b64 v14, v[48:49] offset:0
    ds_write_b64 v14, v[50:51] offset:512
    ds_write_b64 v14, v[52:53] offset:1024
    ds_write_b64 v14, v[54:55] offset:1536
    s_lshl_b32 s13, s12, 10
    v_add_u32 v10, s13, v4
    s_lshl_b32 s13, s21, 9
    s_add_u32 s13, s13, 65536
    v_add_u32 v14, s13, v13
    v_mov_b32 v12, 0x3f80
    v_mov_b32 v11, 0x3f800000
    s_waitcnt lgkmcnt(0)
    s_barrier
    ds_read_b128 v[16:19], v10 offset:0
    ds_read_b128 v[20:23], v10 offset:8192
    ds_read_b128 v[24:27], v10 offset:16384
    ds_read_b128 v[28:31], v10 offset:24576
    ds_read_b128 v[32:35], v10 offset:32768
    ds_read_b128 v[36:39], v10 offset:40960
    ds_read_b128 v[40:43], v10 offset:49152
    ds_read_b128 v[44:47], v10 offset:57344
    ds_read_b64 v[88:89], v14 offset:0
    ds_read_b64 v[90:91], v14 offset:2048
    ds_read_b64 v[92:93], v14 offset:4096
    ds_read_b64 v[94:95], v14 offset:6144
    ds_read_b64 v[96:97], v14 offset:8192
    ds_read_b64 v[98:99], v14 offset:10240
    ds_read_b64 v[100:101], v14 offset:12288
    ds_read_b64 v[102:103], v14 offset:14336
    v_mov_b32 v56, 0
    v_mov_b32 v57, 0
    v_mov_b32 v58, 0
    v_mov_b32 v59, 0
    v_mov_b32 v60, 0
    v_mov_b32 v61, 0
    v_mov_b32 v62, 0
    v_mov_b32 v63, 0
    v_mov_b32 v64, 0
    v_mov_b32 v65, 0
    v_mov_b32 v66, 0
    v_mov_b32 v67, 0
    s_waitcnt lgkmcnt(15)
    v_dot2_f32_bf16 v56, v16, v12, v56
    v_dot2_f32_bf16 v57, v16, v11, v57
    v_dot2_f32_bf16 v60, v18, v12, v60
    v_dot2_f32_bf16 v61, v18, v11, v61
    v_dot2_f32_bf16 v58, v17, v12, v58
    v_dot2_f32_bf16 v59, v17, v11, v59
    v_dot2_f32_bf16 v62, v19, v12, v62
    v_dot2_f32_bf16 v63, v19, v11, v63
    s_waitcnt lgkmcnt(14)
    v_dot2_f32_bf16 v56, v20, v12, v56
    v_dot2_f32_bf16 v57, v20, v11, v57
    v_dot2_f32_bf16 v60, v22, v12, v60
    v_dot2_f32_bf16 v61, v22, v11, v61
    v_dot2_f32_bf16 v58, v21, v12, v58
    v_dot2_f32_bf16 v59, v21, v11, v59
    v_dot2_f32_bf16 v62, v23, v12, v62
    v_dot2_f32_bf16 v63, v23, v11, v63
    s_waitcnt lgkmcnt(13)
    v_dot2_f32_bf16 v56, v24, v12, v56
    v_dot2_f32_bf16 v57, v24, v11, v57
    v_dot2_f32_bf16 v60, v26, v12, v60
    v_dot2_f32_bf16 v61, v26, v11, v61
    v_dot2_f32_bf16 v58, v25, v12, v58
    v_dot2_f32_bf16 v59, v25, v11, v59
    v_dot2_f32_bf16 v62, v27, v12, v62
    v_dot2_f32_bf16 v63, v27, v11, v63
    s_waitcnt lgkmcnt(12)
    v_dot2_f32_bf16 v56, v28, v12, v56
    v_dot2_f32_bf16 v57, v28, v11, v57
    v_dot2_f32_bf16 v60, v30, v12, v60
    v_dot2_f32_bf16 v61, v30, v11, v61
    v_dot2_f32_bf16 v58, v29, v12, v58
    v_dot2_f32_bf16 v59, v29, v11, v59
    v_dot2_f32_bf16 v62, v31, v12, v62
    v_dot2_f32_bf16 v63, v31, v11, v63
    s_waitcnt lgkmcnt(11)
    v_dot2_f32_bf16 v56, v32, v12, v56
    v_dot2_f32_bf16 v57, v32, v11, v57
    v_dot2_f32_bf16 v60, v34, v12, v60
    v_dot2_f32_bf16 v61, v34, v11, v61
    v_dot2_f32_bf16 v58, v33, v12, v58
    v_dot2_f32_bf16 v59, v33, v11, v59
    v_dot2_f32_bf16 v62, v35, v12, v62
    v_dot2_f32_bf16 v63, v35, v11, v63
    s_waitcnt lgkmcnt(10)
    v_dot2_f32_bf16 v56, v36, v12, v56
    v_dot2_f32_bf16 v57, v36, v11, v57
    v_dot2_f32_bf16 v60, v38, v12, v60
    v_dot2_f32_bf16 v61, v38, v11, v61
    v_dot2_f32_bf16 v58, v37, v12, v58
    v_dot2_f32_bf16 v59, v37, v11, v59
    v_dot2_f32_bf16 v62, v39, v12, v62
    v_dot2_f32_bf16 v63, v39, v11, v63
    s_waitcnt lgkmcnt(9)
    v_dot2_f32_bf16 v56, v40, v12, v56
    v_dot2_f32_bf16 v57, v40, v11, v57
    v_dot2_f32_bf16 v60, v42, v12, v60
    v_dot2_f32_bf16 v61, v42, v11, v61
    v_dot2_f32_bf16 v58, v41, v12, v58
    v_dot2_f32_bf16 v59, v41, v11, v59
    v_dot2_f32_bf16 v62, v43, v12, v62
    v_dot2_f32_bf16 v63, v43, v11, v63
    s_waitcnt lgkmcnt(8)
    v_dot2_f32_bf16 v56, v44, v12, v56
    v_dot2_f32_bf16 v57, v44, v11, v57
    v_dot2_f32_bf16 v60, v46, v12, v60
    v_dot2_f32_bf16 v61, v46, v11, v61
    v_dot2_f32_bf16 v58, v45, v12, v58
    v_dot2_f32_bf16 v59, v45, v11, v59
    v_dot2_f32_bf16 v62, v47, v12, v62
    v_dot2_f32_bf16 v63, v47, v11, v63
    s_waitcnt lgkmcnt(0)
    v_dot2_f32_bf16 v64, v88, v12, v64
    v_dot2_f32_bf16 v65, v88, v11, v65
    v_dot2_f32_bf16 v66, v89, v12, v66
    v_dot2_f32_bf16 v67, v89, v11, v67
    v_dot2_f32_bf16 v64, v90, v12, v64
    v_dot2_f32_bf16 v65, v90, v11, v65
    v_dot2_f32_bf16 v66, v91, v12, v66
    v_dot2_f32_bf16 v67, v91, v11, v67
    v_dot2_f32_bf16 v64, v92, v12, v64
    v_dot2_f32_bf16 v65, v92, v11, v65
    v_dot2_f32_bf16 v66, v93, v12, v66
    v_dot2_f32_bf16 v67, v93, v11, v67
    v_dot2_f32_bf16 v64, v94, v12, v64
    v_dot2_f32_bf16 v65, v94, v11, v65
    v_dot2_f32_bf16 v66, v95, v12, v66
    v_dot2_f32_bf16 v67, v95, v11, v67
    v_dot2_f32_bf16 v64, v96, v12, v64
    v_dot2_f32_bf16 v65, v96, v11, v65
    v_dot2_f32_bf16 v66, v97, v12, v66
    v_dot2_f32_bf16 v67, v97, v11, v67
    v_dot2_f32_bf16 v64, v98, v12, v64
    v_dot2_f32_bf16 v65, v98, v11, v65
    v_dot2_f32_bf16 v66, v99, v12, v66
    v_dot2_f32_bf16 v67, v99, v11, v67
    v_dot2_f32_bf16 v64, v100, v12, v64
    v_dot2_f32_bf16 v65, v100, v11, v65
    v_dot2_f32_bf16 v66, v101, v12, v66
    v_dot2_f32_bf16 v67, v101, v11, v67
    v_dot2_f32_bf16 v64, v102, v12, v64
    v_dot2_f32_bf16 v65, v102, v11, v65
    v_dot2_f32_bf16 v66, v103, v12, v66
    v_dot2_f32_bf16 v67, v103, v11, v67
    v_and_b32 v3, 31, v2
    v_mul_u32_u24 v3, 336, v3
    v_lshrrev_b32 v14, 5, v2
    v_lshl_add_u32 v3, v14, 3, v3
    s_lshl_b32 s13, s21, 4
    s_lshl_b32 s14, s22, 6
    s_add_u32 s13, s13, 98304
    s_add_u32 s14, s14, s13
    v_add_u32 v13, s14, v3
    v_add_u32 v14, s13, v3
    s_mov_b32 s44, s48
    s_and_b32 s45, s49, 0xffff
    s_mov_b32 s46, 2621440
    s_mov_b32 s47, 0x20000
    s_nop 3
    v_cvt_pk_bf16_f32 v68, v56, v57
    v_cvt_pk_bf16_f32 v69, v58, v59
    v_cvt_pk_bf16_f32 v70, v60, v61
    v_cvt_pk_bf16_f32 v71, v62, v63
    v_cvt_pk_bf16_f32 v72, v64, v65
    v_cvt_pk_bf16_f32 v73, v66, v67
    ds_write_b64 v13, v[68:69]
    ds_write_b64 v13, v[70:71] offset:128
    s_cmp_eq_u32 s22, 0
    s_cbranch_scc0 gated_mix__mha_block__glu_gated_geglu__prompt_kernel_p2_no4
    ds_write_b64 v14, v[72:73] offset:256
gated_mix__mha_block__glu_gated_geglu__prompt_kernel_p2_no4:
    s_lshl_b32 s13, s12, 6
    v_add_u32 v3, s13, v2
    v_mul_u32_u24 v14, 3277, v3
    v_lshrrev_b32 v14, 16, v14
    v_mul_u32_u24 v15, 20, v14
    v_sub_u32 v15, v3, v15
    v_mul_u32_u24 v16, 336, v14
    v_lshl_add_u32 v16, v15, 4, v16
    v_add_u32 v16, 98304, v16
    v_mul_u32_u24 v17, 1280, v14
    v_lshl_add_u32 v17, v15, 4, v17
    v_add_u32 v3, 512, v3
    v_mul_u32_u24 v14, 3277, v3
    v_lshrrev_b32 v14, 16, v14
    v_mul_u32_u24 v15, 20, v14
    v_sub_u32 v15, v3, v15
    v_mul_u32_u24 v18, 336, v14
    v_lshl_add_u32 v18, v15, 4, v18
    v_add_u32 v18, 98304, v18
    v_mul_u32_u24 v19, 1280, v14
    v_lshl_add_u32 v19, v15, 4, v19
    s_mul_i32 s13, s23, 40960
    s_mul_i32 s14, s24, 320
    s_add_u32 s13, s13, s14
    s_waitcnt lgkmcnt(0)
    s_barrier
    ds_read_b128 v[20:23], v16
    s_cmp_lt_u32 s12, 2
    s_cbranch_scc0 gated_mix__mha_block__glu_gated_geglu__prompt_kernel_p2_one
    ds_read_b128 v[24:27], v18
    s_waitcnt lgkmcnt(0)
    buffer_store_dwordx4 v[24:27], v19, s[44:47], s13 offen
gated_mix__mha_block__glu_gated_geglu__prompt_kernel_p2_one:
    s_waitcnt lgkmcnt(0)
    buffer_store_dwordx4 v[20:23], v17, s[44:47], s13 offen
gated_mix__mha_block__glu_gated_geglu__prompt_kernel_p2_fin:
gated_mix__mha_block__glu_gated_geglu__prompt_kernel_end:
    s_endpgm
.section .rodata,"a"
.p2align 6
.amdhsa_kernel gated_mix__mha_block__glu_gated_geglu__prompt_kernel
  .amdhsa_next_free_vgpr 256
  .amdhsa_next_free_sgpr 102
  .amdhsa_accum_offset 256
  .amdhsa_group_segment_fixed_size 0
  .amdhsa_kernarg_size 88
  .amdhsa_user_sgpr_count 2
  .amdhsa_user_sgpr_kernarg_segment_ptr 1
  .amdhsa_system_sgpr_workgroup_id_x 1
  .amdhsa_float_denorm_mode_32 3
.end_amdhsa_kernel
```
